```python
import torch

def _softmax(x, axis=-1):
    return torch.softmax(x, dim=axis)
def _gelu(x):
    return torch.nn.functional.gelu(x, approximate="tanh")
def _silu(x):
    return torch.nn.functional.silu(x)
def _sigmoid(x):
    return torch.sigmoid(x)
def _layernorm(x, axis=-1, eps=1e-5):
    m = x.mean(dim=axis, keepdim=True)
    v = x.var(dim=axis, keepdim=True, unbiased=False)
    return (x - m) / torch.sqrt(v + eps)
def _scatter_add(tgt, idx, src, axis=0):
    return tgt.clone().index_add_(axis, idx, src)
def _segment_sum(src, seg, n):
    out = torch.zeros((n,) + src.shape[1:], dtype=src.dtype)
    return out.index_add_(0, seg, src)
def _pad(x, pw):
    flat = tuple(v for pair in reversed(pw) for v in pair)
    return torch.nn.functional.pad(x, flat)

kernel_name = 'sequential_preLN__spectral_fnet__dense_activation_squared_relu__prompt'

def setup_inputs():

    _w = (lambda a: (lambda t: t.to(torch.bfloat16) if t.is_floating_point() else t)(torch.as_tensor(a)))
    def _A_setup():
        B, S, D = 1, 2048, 640
        ns = torch.arange(S)[:, None] * torch.arange(S)[None, :]
        nd = torch.arange(D)[:, None] * torch.arange(D)[None, :]
        Ws_re = torch.cos(-2.0 * torch.pi * ns / S).to(float)
        Ws_im = torch.sin(-2.0 * torch.pi * ns / S).to(float)
        Wd_re = torch.cos(-2.0 * torch.pi * nd / D).to(float)
        Wd_im = torch.sin(-2.0 * torch.pi * nd / D).to(float)
        return {
            "x": _w((lambda *s: torch.randn(*s, dtype=torch.bfloat16) * 0.05)(B, S, D)),
            "dft_seq_re": _w(Ws_re),
            "dft_seq_im": _w(Ws_im),
            "dft_hid_re": _w(Wd_re),
            "dft_hid_im": _w(Wd_im),
        }
    _A_in = _A_setup()

    def _B_setup():
        B, S, D, F = 1, 2048, 640, 1728
        return {
            "x": _w((lambda *s: torch.randn(*s, dtype=torch.bfloat16) * 0.05)(B, S, D)),
            "w1": _w((lambda *s: torch.randn(*s, dtype=torch.bfloat16) * 0.2)(D, F)),
            "b1": _w((lambda *s: torch.randn(*s, dtype=torch.bfloat16) * 0.2)(F)),
            "w2": _w((lambda *s: torch.randn(*s, dtype=torch.bfloat16) * 0.2)(F, D)),
            "b2": _w((lambda *s: torch.randn(*s, dtype=torch.bfloat16) * 0.2)(D)),
        }
    _B_in = _B_setup()

    return {
        "A_x": _A_in["x"],
        "A_dft_seq_re": _A_in["dft_seq_re"],
        "A_dft_seq_im": _A_in["dft_seq_im"],
        "A_dft_hid_re": _A_in["dft_hid_re"],
        "A_dft_hid_im": _A_in["dft_hid_im"],
        "B_x": _B_in["x"],
        "B_w1": _B_in["w1"],
        "B_b1": _B_in["b1"],
        "B_w2": _B_in["w2"],
        "B_b2": _B_in["b2"],
    }

def reference(A_x, A_dft_seq_re, A_dft_seq_im, A_dft_hid_re, A_dft_hid_im, B_x, B_w1, B_b1, B_w2, B_b2):
    def _A_ref(x, dft_seq_re, dft_seq_im, dft_hid_re, dft_hid_im):
        a = torch.einsum("bsd,ed->bse", x, dft_hid_re)
        b = torch.einsum("bsd,ed->bse", x, dft_hid_im)
        y = torch.einsum("ts,bse->bte", dft_seq_re, a) - torch.einsum("ts,bse->bte", dft_seq_im, b)
        return y

    def _B_ref(x, w1, b1, w2, b2):
        h = torch.einsum("bsd,df->bsf", x, w1) + b1
        zero = torch.zeros_like(h)
        r = torch.where(h > zero, h, zero)
        h = r * r
        out = torch.einsum("bsf,fd->bsd", h, w2) + b2
        return out

    x = A_x
    h = x + _A_ref(_layernorm(x, axis=-1), A_dft_seq_re, A_dft_seq_im, A_dft_hid_re, A_dft_hid_im)
    h2 = h + _B_ref(_layernorm(h, axis=-1), B_w1, B_b1, B_w2, B_b2)
    return h2
```

```asm
; @launch grid=(256,1,1) block=(512,1,1) lds=163840
.amdgcn_target "amdgcn-amd-amdhsa--gfx950"
.text
.globl sequential_preLN__spectral_fnet__dense_activation_squared_relu__prompt_kernel
.p2align 8
.type sequential_preLN__spectral_fnet__dense_activation_squared_relu__prompt_kernel,@function
sequential_preLN__spectral_fnet__dense_activation_squared_relu__prompt_kernel:
    s_cmp_ge_u32 s2, 256
    s_cbranch_scc1 K2_END
    s_load_dwordx2 s[12:13], s[0:1], 0
    s_load_dwordx2 s[16:17], s[0:1], 48
    s_load_dwordx2 s[20:21], s[0:1], 88
    s_load_dwordx2 s[24:25], s[0:1], 96
    v_lshrrev_b32 v89, 6, v0
    v_and_b32 v88, 63, v0
    v_readfirstlane_b32 s28, v89
    s_and_b32 s29, s2, 7
    s_lshr_b32 s30, s2, 3
    s_mov_b32 s14, 2621440
    s_mov_b32 s15, 0x20000
    s_mov_b32 s18, 2211840
    s_mov_b32 s19, 0x20000
    s_mov_b32 s22, 256
    s_mov_b32 s23, 0x20000
    s_mov_b32 s26, 12921856
    s_mov_b32 s27, 0x20000
    s_getpc_b64 s[4:5]
K1_PC:
    v_lshlrev_b32 v90, 4, v0
    global_load_dwordx4 v[84:87], v90, s[4:5]
    s_cmp_lg_u32 s28, 7
    s_cbranch_scc1 K1_NCP
    s_lshl_b32 s33, s30, 10
    s_add_u32 s33, s33, 1024
    v_add_u32 v90, s33, v90
    v_min_u32 v90, CODE_END-K1_PC-16, v90
    global_load_dwordx4 v[84:87], v90, s[4:5]
K1_NCP:
    s_mul_i32 s33, s30, 43
    s_lshr_b32 s33, s33, 8
    s_lshl_b32 s31, s33, 3
    s_add_u32 s31, s31, s29
    s_mul_i32 s33, s33, 6
    s_sub_u32 s32, s30, s33
    v_lshlrev_b32 v120, 4, v88
    s_cmp_gt_u32 s31, 32
    s_cbranch_scc1 K1_SPARE
    s_add_u32 s33, s28, s32
    s_cmp_ge_u32 s32, 3
    s_addc_u32 s33, s33, 0
    s_and_b32 s39, s33, 7
    v_lshrrev_b32 v89, 4, v88
    s_lshl_b32 s33, s39, 8
    s_add_u32 s33, s33, s31
    v_lshl_add_u32 v90, v89, 6, s33
    v_sub_u32 v91, 0x800, v90
    v_and_b32 v91, 0x7ff, v91
    v_and_b32 v92, 8, v88
    v_cmp_ne_u32 s[34:35], 0, v92
    v_and_b32 v92, 7, v88
    s_nop 0
    v_cndmask_b32 v90, v90, v91, s[34:35]
    v_mul_u32_u24 v90, 1280, v90
    v_lshl_add_u32 v93, v92, 4, v90
    s_cmp_ge_u32 s32, 3
    s_cselect_b32 s36, 1, 0
    s_mul_i32 s33, s36, 3
    s_sub_u32 s33, s32, s33
    s_mul_i32 s37, s33, 3
    s_cmp_eq_u32 s33, 0
    s_cselect_b32 s38, 4, 3
    s_cselect_b32 s33, 0, 1
    s_add_u32 s37, s37, s33
    s_add_u32 s37, s37, s28
    s_and_b32 s33, s39, 3
    s_lshl_b32 s33, s33, 2
    v_add_u32 v91, s33, v89
    v_xor_b32 v91, v91, v92
    v_lshlrev_b32 v91, 4, v91
    v_lshl_add_u32 v91, v92, 8, v91
    s_lshr_b32 s33, s39, 2
    s_mul_i32 s33, s33, 10240
    v_mov_b32 v90, 20480
    v_cndmask_b32 v90, 0, v90, s[34:35]
    v_add3_u32 v94, v91, v90, s33
    v_mov_b32 v95, 0
    v_mov_b32 v90, 73728
    v_mov_b32 v96, 0
    v_mov_b32 v97, 0
    ds_write_b64 v90, v[96:97]
    ds_write_b64 v90, v[96:97] offset:8
    s_mov_b64 s[82:83], s[34:35]
    s_mov_b32 s84, 0x3f803f80
    s_lshl_b32 s85, s36, 15
    s_or_b32 s85, s85, 0x3f80
    s_lshl_b32 s86, s85, 16
    s_cmp_eq_u32 s36, 0
    s_cselect_b32 s87, -2.0, 0
    s_mov_b32 s89, 0
    s_cmp_ge_u32 s28, s38
    s_cselect_b32 s88, 1, 0
    s_cmp_lt_u32 s28, 4
    s_cbranch_scc1 K1_XLD
    s_mov_b32 s89, 1
    s_waitcnt lgkmcnt(0)
    s_branch PB
K1_XLD:
    s_waitcnt lgkmcnt(0)
    buffer_load_dwordx4 v[4:7], v93, s[12:15], 0 offen offset:0
    buffer_load_dwordx4 v[8:11], v93, s[12:15], 0 offen offset:640
    buffer_load_dwordx4 v[12:15], v93, s[12:15], 0 offen offset:128
    buffer_load_dwordx4 v[16:19], v93, s[12:15], 0 offen offset:768
    buffer_load_dwordx4 v[20:23], v93, s[12:15], 0 offen offset:256
    buffer_load_dwordx4 v[24:27], v93, s[12:15], 0 offen offset:896
    buffer_load_dwordx4 v[28:31], v93, s[12:15], 0 offen offset:384
    buffer_load_dwordx4 v[32:35], v93, s[12:15], 0 offen offset:1024
    buffer_load_dwordx4 v[36:39], v93, s[12:15], 0 offen offset:512
    buffer_load_dwordx4 v[40:43], v93, s[12:15], 0 offen offset:1152
    s_cmp_eq_u32 s88, 1
    s_cbranch_scc1 K1_NOGEN
    s_branch K1_GEN
K1_SPARE:
    s_sub_u32 s31, s30, 24
    s_min_u32 s33, s31, 5
    s_sub_u32 s32, s2, 193
    s_sub_u32 s32, s32, s33
    s_cmp_lt_u32 s32, 54
    s_cbranch_scc1 K1_SP1
    v_mov_b32 v96, 0
    v_mov_b32 v97, 0
    v_mov_b32 v98, 0
    v_mov_b32 v99, 0
    s_and_b32 s50, s32, 1
    s_lshl_b32 s50, s50, 3
    s_add_u32 s50, s50, s28
    s_mul_i32 s51, s50, 1280
    s_add_u32 s51, s51, 5819392
    s_mul_i32 s50, s50, 3072
    s_add_u32 s50, s50, 5770240
    s_cmp_ge_u32 s32, 56
    s_cselect_b32 s50, s51, s50
    s_waitcnt lgkmcnt(0)
    buffer_store_dwordx4 v[96:99], v120, s[24:27], s50 offen sc0 sc1
    s_cselect_b64 exec, 0xffff, -1
    buffer_store_dwordx4 v[96:99], v120, s[24:27], s50 offen offset:1024 sc0 sc1
    s_mov_b64 exec, -1
    s_cbranch_scc1 K1_SP2
    buffer_store_dwordx4 v[96:99], v120, s[24:27], s50 offen offset:2048 sc0 sc1
    s_branch K1_SP2
K1_SP1:
    v_lshrrev_b32 v89, 3, v88
    v_and_b32 v90, 7, v88
    v_and_b32 v91, 2, v89
    v_xor_b32 v90, v90, v91
    s_and_b32 s33, s28, 1
    s_lshl_b32 s33, s33, 2
    v_xor_b32 v90, s33, v90
    v_mul_u32_u24 v91, 3456, v89
    v_lshl_add_u32 v121, v90, 4, v91
    v_xor_b32 v90, 4, v90
    v_lshl_add_u32 v122, v90, 4, v91
    s_mul_i32 s51, s28, 40
    s_sub_u32 s55, 633, s51
    s_bitcmp1_b32 s32, 0
    s_cselect_b32 s51, s55, s51
    s_cselect_b32 s59, -1, 1
    s_mul_i32 s59, s59, 27648
    s_cmp_eq_u32 s51, 633
    s_cselect_b32 s56, 1105920, 0
    s_mul_i32 s51, s51, 3456
    s_lshr_b32 s52, s32, 1
    s_lshl_b32 s57, s52, 7
    s_add_u32 s51, s51, s57
    v_add_u32 v123, s51, v121
    v_subrev_u32 v90, s56, v123
    v_cmp_eq_u32 vcc, 7, v89
    s_mul_i32 s50, s28, 5120
    s_nop 0
    v_cndmask_b32 v123, v123, v90, vcc
    s_add_u32 m0, s50, 0
    s_waitcnt lgkmcnt(0)
    buffer_load_dwordx4 v123, s[16:19], 0 offen nt lds
    s_add_u32 m0, s50, 1024
    s_add_u32 s51, s51, s59
    buffer_load_dwordx4 v122, s[16:19], s51 offen nt lds
    s_add_u32 m0, s50, 2048
    s_add_u32 s51, s51, s59
    buffer_load_dwordx4 v121, s[16:19], s51 offen nt lds
    s_add_u32 m0, s50, 3072
    s_add_u32 s51, s51, s59
    buffer_load_dwordx4 v122, s[16:19], s51 offen nt lds
    s_add_u32 m0, s50, 4096
    s_add_u32 s51, s51, s59
    buffer_load_dwordx4 v121, s[16:19], s51 offen nt lds
    s_branch K1_SP2
K1_GEN:
    v_and_b32 v91, 15, v88
    s_lshl_b32 s33, s37, 5
    s_add_u32 s33, s33, s36
    v_lshl_add_u32 v90, v91, 1, s33
    v_mov_b32 v92, 320
    v_cmp_eq_u32 vcc, 0, v90
    s_nop 1
    v_cndmask_b32 v90, v90, v92, vcc
    v_cvt_f32_u32 v90, v90
    v_mul_f32 v232, 0xbacccccd, v90
    v_lshlrev_b32 v92, 3, v89
    v_cvt_f32_u32 v92, v92
    v_mul_f32 v233, v232, v92
    v_mov_b32 v96, v233
    v_fmamk_f32 v97, v232, 0x3f800000, v233
    v_fmamk_f32 v98, v232, 0x40000000, v233
    v_fmamk_f32 v99, v232, 0x40400000, v233
    v_fmamk_f32 v100, v232, 0x40800000, v233
    v_fmamk_f32 v101, v232, 0x40a00000, v233
    v_fmamk_f32 v102, v232, 0x40c00000, v233
    v_fmamk_f32 v103, v232, 0x40e00000, v233
    v_cos_f32 v104, v96
    v_sin_f32 v112, v96
    v_cos_f32 v105, v97
    v_sin_f32 v113, v97
    v_cos_f32 v106, v98
    v_sin_f32 v114, v98
    v_cos_f32 v107, v99
    v_sin_f32 v115, v99
    v_cos_f32 v108, v100
    v_sin_f32 v116, v100
    v_cos_f32 v109, v101
    v_sin_f32 v117, v101
    v_cos_f32 v110, v102
    v_sin_f32 v118, v102
    v_cos_f32 v111, v103
    v_sin_f32 v119, v103
    v_cvt_pk_f16_f32 v128, v104, v105
    v_cvt_pk_f16_f32 v129, v106, v107
    v_cvt_pk_f16_f32 v130, v108, v109
    v_cvt_pk_f16_f32 v131, v110, v111
    v_cvt_pk_f16_f32 v148, v112, v113
    v_cvt_pk_f16_f32 v149, v114, v115
    v_cvt_pk_f16_f32 v150, v116, v117
    v_cvt_pk_f16_f32 v151, v118, v119
    v_fmamk_f32 v96, v232, 0x42000000, v233
    v_fmamk_f32 v97, v232, 0x42040000, v233
    v_fmamk_f32 v98, v232, 0x42080000, v233
    v_fmamk_f32 v99, v232, 0x420c0000, v233
    v_fmamk_f32 v100, v232, 0x42100000, v233
    v_fmamk_f32 v101, v232, 0x42140000, v233
    v_fmamk_f32 v102, v232, 0x42180000, v233
    v_fmamk_f32 v103, v232, 0x421c0000, v233
    v_cos_f32 v104, v96
    v_sin_f32 v112, v96
    v_cos_f32 v105, v97
    v_sin_f32 v113, v97
    v_cos_f32 v106, v98
    v_sin_f32 v114, v98
    v_cos_f32 v107, v99
    v_sin_f32 v115, v99
    v_cos_f32 v108, v100
    v_sin_f32 v116, v100
    v_cos_f32 v109, v101
    v_sin_f32 v117, v101
    v_cos_f32 v110, v102
    v_sin_f32 v118, v102
    v_cos_f32 v111, v103
    v_sin_f32 v119, v103
    v_cvt_pk_f16_f32 v132, v104, v105
    v_cvt_pk_f16_f32 v133, v106, v107
    v_cvt_pk_f16_f32 v134, v108, v109
    v_cvt_pk_f16_f32 v135, v110, v111
    v_cvt_pk_f16_f32 v152, v112, v113
    v_cvt_pk_f16_f32 v153, v114, v115
    v_cvt_pk_f16_f32 v154, v116, v117
    v_cvt_pk_f16_f32 v155, v118, v119
    v_fmamk_f32 v96, v232, 0x42800000, v233
    v_fmamk_f32 v97, v232, 0x42820000, v233
    v_fmamk_f32 v98, v232, 0x42840000, v233
    v_fmamk_f32 v99, v232, 0x42860000, v233
    v_fmamk_f32 v100, v232, 0x42880000, v233
    v_fmamk_f32 v101, v232, 0x428a0000, v233
    v_fmamk_f32 v102, v232, 0x428c0000, v233
    v_fmamk_f32 v103, v232, 0x428e0000, v233
    v_cos_f32 v104, v96
    v_sin_f32 v112, v96
    v_cos_f32 v105, v97
    v_sin_f32 v113, v97
    v_cos_f32 v106, v98
    v_sin_f32 v114, v98
    v_cos_f32 v107, v99
    v_sin_f32 v115, v99
    v_cos_f32 v108, v100
    v_sin_f32 v116, v100
    v_cos_f32 v109, v101
    v_sin_f32 v117, v101
    v_cos_f32 v110, v102
    v_sin_f32 v118, v102
    v_cos_f32 v111, v103
    v_sin_f32 v119, v103
    v_cvt_pk_f16_f32 v136, v104, v105
    v_cvt_pk_f16_f32 v137, v106, v107
    v_cvt_pk_f16_f32 v138, v108, v109
    v_cvt_pk_f16_f32 v139, v110, v111
    v_cvt_pk_f16_f32 v156, v112, v113
    v_cvt_pk_f16_f32 v157, v114, v115
    v_cvt_pk_f16_f32 v158, v116, v117
    v_cvt_pk_f16_f32 v159, v118, v119
    v_fmamk_f32 v96, v232, 0x42c00000, v233
    v_fmamk_f32 v97, v232, 0x42c20000, v233
    v_fmamk_f32 v98, v232, 0x42c40000, v233
    v_fmamk_f32 v99, v232, 0x42c60000, v233
    v_fmamk_f32 v100, v232, 0x42c80000, v233
    v_fmamk_f32 v101, v232, 0x42ca0000, v233
    v_fmamk_f32 v102, v232, 0x42cc0000, v233
    v_fmamk_f32 v103, v232, 0x42ce0000, v233
    v_cos_f32 v104, v96
    v_sin_f32 v112, v96
    v_cos_f32 v105, v97
    v_sin_f32 v113, v97
    v_cos_f32 v106, v98
    v_sin_f32 v114, v98
    v_cos_f32 v107, v99
    v_sin_f32 v115, v99
    v_cos_f32 v108, v100
    v_sin_f32 v116, v100
    v_cos_f32 v109, v101
    v_sin_f32 v117, v101
    v_cos_f32 v110, v102
    v_sin_f32 v118, v102
    v_cos_f32 v111, v103
    v_sin_f32 v119, v103
    v_cvt_pk_f16_f32 v140, v104, v105
    v_cvt_pk_f16_f32 v141, v106, v107
    v_cvt_pk_f16_f32 v142, v108, v109
    v_cvt_pk_f16_f32 v143, v110, v111
    v_cvt_pk_f16_f32 v160, v112, v113
    v_cvt_pk_f16_f32 v161, v114, v115
    v_cvt_pk_f16_f32 v162, v116, v117
    v_cvt_pk_f16_f32 v163, v118, v119
    v_fmamk_f32 v96, v232, 0x43000000, v233
    v_fmamk_f32 v97, v232, 0x43010000, v233
    v_fmamk_f32 v98, v232, 0x43020000, v233
    v_fmamk_f32 v99, v232, 0x43030000, v233
    v_fmamk_f32 v100, v232, 0x43040000, v233
    v_fmamk_f32 v101, v232, 0x43050000, v233
    v_fmamk_f32 v102, v232, 0x43060000, v233
    v_fmamk_f32 v103, v232, 0x43070000, v233
    v_cos_f32 v104, v96
    v_sin_f32 v112, v96
    v_cos_f32 v105, v97
    v_sin_f32 v113, v97
    v_cos_f32 v106, v98
    v_sin_f32 v114, v98
    v_cos_f32 v107, v99
    v_sin_f32 v115, v99
    v_cos_f32 v108, v100
    v_sin_f32 v116, v100
    v_cos_f32 v109, v101
    v_sin_f32 v117, v101
    v_cos_f32 v110, v102
    v_sin_f32 v118, v102
    v_cos_f32 v111, v103
    v_sin_f32 v119, v103
    v_cvt_pk_f16_f32 v144, v104, v105
    v_cvt_pk_f16_f32 v145, v106, v107
    v_cvt_pk_f16_f32 v146, v108, v109
    v_cvt_pk_f16_f32 v147, v110, v111
    v_cvt_pk_f16_f32 v164, v112, v113
    v_cvt_pk_f16_f32 v165, v114, v115
    v_cvt_pk_f16_f32 v166, v116, v117
    v_cvt_pk_f16_f32 v167, v118, v119
    v_lshl_add_u32 v92, v89, 8, s31
    v_cvt_f32_u32 v92, v92
    v_mul_f32 v92, 0x3c800000, v92
    v_add_u32 v90, 0, v91
    v_cvt_f32_u32 v90, v90
    v_mul_f32 v232, 0x3d000000, v90
    v_mul_f32 v233, v232, v92
    v_mov_b32 v96, v233
    v_fmamk_f32 v97, v232, 0x3f800000, v233
    v_fmamk_f32 v98, v232, 0x40000000, v233
    v_fmamk_f32 v99, v232, 0x40400000, v233
    v_fmamk_f32 v100, v232, 0x41800000, v233
    v_fmamk_f32 v101, v232, 0x41880000, v233
    v_fmamk_f32 v102, v232, 0x41900000, v233
    v_fmamk_f32 v103, v232, 0x41980000, v233
    v_cos_f32 v104, v96
    v_sin_f32 v112, v96
    v_cos_f32 v105, v97
    v_sin_f32 v113, v97
    v_cos_f32 v106, v98
    v_sin_f32 v114, v98
    v_cos_f32 v107, v99
    v_sin_f32 v115, v99
    v_cos_f32 v108, v100
    v_sin_f32 v116, v100
    v_cos_f32 v109, v101
    v_sin_f32 v117, v101
    v_cos_f32 v110, v102
    v_sin_f32 v118, v102
    v_cos_f32 v111, v103
    v_sin_f32 v119, v103
    v_cvt_pk_f16_f32 v168, v104, v105
    v_cvt_pk_f16_f32 v169, v106, v107
    v_cvt_pk_f16_f32 v170, v108, v109
    v_cvt_pk_f16_f32 v171, v110, v111
    v_cvt_pk_f16_f32 v176, v112, v113
    v_cvt_pk_f16_f32 v177, v114, v115
    v_cvt_pk_f16_f32 v178, v116, v117
    v_cvt_pk_f16_f32 v179, v118, v119
    v_xor_b32 v184, 0x80008000, v176
    v_xor_b32 v185, 0x80008000, v177
    v_xor_b32 v186, 0x80008000, v178
    v_xor_b32 v187, 0x80008000, v179
    v_add_u32 v90, 16, v91
    v_cvt_f32_u32 v90, v90
    v_mul_f32 v232, 0x3d000000, v90
    v_mul_f32 v233, v232, v92
    v_mov_b32 v96, v233
    v_fmamk_f32 v97, v232, 0x3f800000, v233
    v_fmamk_f32 v98, v232, 0x40000000, v233
    v_fmamk_f32 v99, v232, 0x40400000, v233
    v_fmamk_f32 v100, v232, 0x41800000, v233
    v_fmamk_f32 v101, v232, 0x41880000, v233
    v_fmamk_f32 v102, v232, 0x41900000, v233
    v_fmamk_f32 v103, v232, 0x41980000, v233
    v_cos_f32 v104, v96
    v_sin_f32 v112, v96
    v_cos_f32 v105, v97
    v_sin_f32 v113, v97
    v_cos_f32 v106, v98
    v_sin_f32 v114, v98
    v_cos_f32 v107, v99
    v_sin_f32 v115, v99
    v_cos_f32 v108, v100
    v_sin_f32 v116, v100
    v_cos_f32 v109, v101
    v_sin_f32 v117, v101
    v_cos_f32 v110, v102
    v_sin_f32 v118, v102
    v_cos_f32 v111, v103
    v_sin_f32 v119, v103
    v_cvt_pk_f16_f32 v172, v104, v105
    v_cvt_pk_f16_f32 v173, v106, v107
    v_cvt_pk_f16_f32 v174, v108, v109
    v_cvt_pk_f16_f32 v175, v110, v111
    v_cvt_pk_f16_f32 v180, v112, v113
    v_cvt_pk_f16_f32 v181, v114, v115
    v_cvt_pk_f16_f32 v182, v116, v117
    v_cvt_pk_f16_f32 v183, v118, v119
    v_xor_b32 v188, 0x80008000, v180
    v_xor_b32 v189, 0x80008000, v181
    v_xor_b32 v190, 0x80008000, v182
    v_xor_b32 v191, 0x80008000, v183
    v_xor_b32 v90, v91, v89
    v_lshlrev_b32 v90, 4, v90
    v_lshl_add_u32 v192, v89, 8, v90
    v_xor_b32 v193, 64, v192
    s_mul_i32 s33, s36, 20480
    s_sub_u32 s39, 20480, s33
    v_add_u32 v194, s33, v192
    v_add_u32 v195, s33, v193
    v_add_u32 v196, s39, v192
    v_add_u32 v197, s39, v193
    v_lshlrev_b32 v90, 31, v91
    v_or_b32 v90, 1.0, v90
    s_cmp_eq_u32 s36, 0
    s_cselect_b64 s[40:41], -1, 0
    v_cndmask_b32 v198, 0, v90, s[40:41]
    v_cndmask_b32 v199, v90, 0, s[40:41]
    v_mul_u32_u24 v95, 40960, v91
    v_lshl_add_u32 v95, v89, 4, v95
    s_lshl_b32 s33, s37, 12
    s_and_b32 s44, s31, 31
    s_lshl_b32 s44, s44, 6
    s_lshl_b32 s45, s36, 11
    s_add_u32 s44, s44, s45
    s_add_u32 s46, s33, s44
    s_add_u32 s47, s46, 655360
K1_NOGEN:
    v_mov_b32 v96, 0
    v_mov_b32 v97, 0
    v_mov_b32 v98, 0
    v_mov_b32 v99, 0
    s_waitcnt vmcnt(9)
    v_lshlrev_b32 v44, 16, v4
    v_and_b32 v45, 0xffff0000, v4
    v_lshlrev_b32 v46, 16, v5
    v_and_b32 v47, 0xffff0000, v5
    v_lshlrev_b32 v48, 16, v6
    v_and_b32 v49, 0xffff0000, v6
    v_lshlrev_b32 v50, 16, v7
    v_and_b32 v51, 0xffff0000, v7
    v_dot2_f32_bf16 v96, v4, v4, v96
    v_dot2_f32_bf16 v98, v4, s84, v98
    v_dot2_f32_bf16 v96, v5, v5, v96
    v_dot2_f32_bf16 v98, v5, s84, v98
    v_dot2_f32_bf16 v96, v6, v6, v96
    v_dot2_f32_bf16 v98, v6, s84, v98
    v_dot2_f32_bf16 v96, v7, v7, v96
    v_dot2_f32_bf16 v98, v7, s84, v98
    s_waitcnt vmcnt(8)
    v_dot2_f32_bf16 v44, v8, s85, v44
    v_dot2_f32_bf16 v45, v8, s86, v45
    v_dot2_f32_bf16 v97, v8, v8, v97
    v_dot2_f32_bf16 v99, v8, s84, v99
    v_dot2_f32_bf16 v46, v9, s85, v46
    v_dot2_f32_bf16 v47, v9, s86, v47
    v_dot2_f32_bf16 v97, v9, v9, v97
    v_dot2_f32_bf16 v99, v9, s84, v99
    v_dot2_f32_bf16 v48, v10, s85, v48
    v_dot2_f32_bf16 v49, v10, s86, v49
    v_dot2_f32_bf16 v97, v10, v10, v97
    v_dot2_f32_bf16 v99, v10, s84, v99
    v_dot2_f32_bf16 v50, v11, s85, v50
    v_dot2_f32_bf16 v51, v11, s86, v51
    v_dot2_f32_bf16 v97, v11, v11, v97
    v_dot2_f32_bf16 v99, v11, s84, v99
    s_waitcnt vmcnt(7)
    v_lshlrev_b32 v52, 16, v12
    v_and_b32 v53, 0xffff0000, v12
    v_lshlrev_b32 v54, 16, v13
    v_and_b32 v55, 0xffff0000, v13
    v_lshlrev_b32 v56, 16, v14
    v_and_b32 v57, 0xffff0000, v14
    v_lshlrev_b32 v58, 16, v15
    v_and_b32 v59, 0xffff0000, v15
    v_dot2_f32_bf16 v96, v12, v12, v96
    v_dot2_f32_bf16 v98, v12, s84, v98
    v_dot2_f32_bf16 v96, v13, v13, v96
    v_dot2_f32_bf16 v98, v13, s84, v98
    v_dot2_f32_bf16 v96, v14, v14, v96
    v_dot2_f32_bf16 v98, v14, s84, v98
    v_dot2_f32_bf16 v96, v15, v15, v96
    v_dot2_f32_bf16 v98, v15, s84, v98
    s_waitcnt vmcnt(6)
    v_dot2_f32_bf16 v52, v16, s85, v52
    v_dot2_f32_bf16 v53, v16, s86, v53
    v_dot2_f32_bf16 v97, v16, v16, v97
    v_dot2_f32_bf16 v99, v16, s84, v99
    v_dot2_f32_bf16 v54, v17, s85, v54
    v_dot2_f32_bf16 v55, v17, s86, v55
    v_dot2_f32_bf16 v97, v17, v17, v97
    v_dot2_f32_bf16 v99, v17, s84, v99
    v_dot2_f32_bf16 v56, v18, s85, v56
    v_dot2_f32_bf16 v57, v18, s86, v57
    v_dot2_f32_bf16 v97, v18, v18, v97
    v_dot2_f32_bf16 v99, v18, s84, v99
    v_dot2_f32_bf16 v58, v19, s85, v58
    v_dot2_f32_bf16 v59, v19, s86, v59
    v_dot2_f32_bf16 v97, v19, v19, v97
    v_dot2_f32_bf16 v99, v19, s84, v99
    s_waitcnt vmcnt(5)
    v_lshlrev_b32 v60, 16, v20
    v_and_b32 v61, 0xffff0000, v20
    v_lshlrev_b32 v62, 16, v21
    v_and_b32 v63, 0xffff0000, v21
    v_lshlrev_b32 v64, 16, v22
    v_and_b32 v65, 0xffff0000, v22
    v_lshlrev_b32 v66, 16, v23
    v_and_b32 v67, 0xffff0000, v23
    v_dot2_f32_bf16 v96, v20, v20, v96
    v_dot2_f32_bf16 v98, v20, s84, v98
    v_dot2_f32_bf16 v96, v21, v21, v96
    v_dot2_f32_bf16 v98, v21, s84, v98
    v_dot2_f32_bf16 v96, v22, v22, v96
    v_dot2_f32_bf16 v98, v22, s84, v98
    v_dot2_f32_bf16 v96, v23, v23, v96
    v_dot2_f32_bf16 v98, v23, s84, v98
    s_waitcnt vmcnt(4)
    v_dot2_f32_bf16 v60, v24, s85, v60
    v_dot2_f32_bf16 v61, v24, s86, v61
    v_dot2_f32_bf16 v97, v24, v24, v97
    v_dot2_f32_bf16 v99, v24, s84, v99
    v_dot2_f32_bf16 v62, v25, s85, v62
    v_dot2_f32_bf16 v63, v25, s86, v63
    v_dot2_f32_bf16 v97, v25, v25, v97
    v_dot2_f32_bf16 v99, v25, s84, v99
    v_dot2_f32_bf16 v64, v26, s85, v64
    v_dot2_f32_bf16 v65, v26, s86, v65
    v_dot2_f32_bf16 v97, v26, v26, v97
    v_dot2_f32_bf16 v99, v26, s84, v99
    v_dot2_f32_bf16 v66, v27, s85, v66
    v_dot2_f32_bf16 v67, v27, s86, v67
    v_dot2_f32_bf16 v97, v27, v27, v97
    v_dot2_f32_bf16 v99, v27, s84, v99
    s_waitcnt vmcnt(3)
    v_lshlrev_b32 v68, 16, v28
    v_and_b32 v69, 0xffff0000, v28
    v_lshlrev_b32 v70, 16, v29
    v_and_b32 v71, 0xffff0000, v29
    v_lshlrev_b32 v72, 16, v30
    v_and_b32 v73, 0xffff0000, v30
    v_lshlrev_b32 v74, 16, v31
    v_and_b32 v75, 0xffff0000, v31
    v_dot2_f32_bf16 v96, v28, v28, v96
    v_dot2_f32_bf16 v98, v28, s84, v98
    v_dot2_f32_bf16 v96, v29, v29, v96
    v_dot2_f32_bf16 v98, v29, s84, v98
    v_dot2_f32_bf16 v96, v30, v30, v96
    v_dot2_f32_bf16 v98, v30, s84, v98
    v_dot2_f32_bf16 v96, v31, v31, v96
    v_dot2_f32_bf16 v98, v31, s84, v98
    s_waitcnt vmcnt(2)
    v_dot2_f32_bf16 v68, v32, s85, v68
    v_dot2_f32_bf16 v69, v32, s86, v69
    v_dot2_f32_bf16 v97, v32, v32, v97
    v_dot2_f32_bf16 v99, v32, s84, v99
    v_dot2_f32_bf16 v70, v33, s85, v70
    v_dot2_f32_bf16 v71, v33, s86, v71
    v_dot2_f32_bf16 v97, v33, v33, v97
    v_dot2_f32_bf16 v99, v33, s84, v99
    v_dot2_f32_bf16 v72, v34, s85, v72
    v_dot2_f32_bf16 v73, v34, s86, v73
    v_dot2_f32_bf16 v97, v34, v34, v97
    v_dot2_f32_bf16 v99, v34, s84, v99
    v_dot2_f32_bf16 v74, v35, s85, v74
    v_dot2_f32_bf16 v75, v35, s86, v75
    v_dot2_f32_bf16 v97, v35, v35, v97
    v_dot2_f32_bf16 v99, v35, s84, v99
    s_waitcnt vmcnt(1)
    v_lshlrev_b32 v76, 16, v36
    v_and_b32 v77, 0xffff0000, v36
    v_lshlrev_b32 v78, 16, v37
    v_and_b32 v79, 0xffff0000, v37
    v_lshlrev_b32 v80, 16, v38
    v_and_b32 v81, 0xffff0000, v38
    v_lshlrev_b32 v82, 16, v39
    v_and_b32 v83, 0xffff0000, v39
    v_dot2_f32_bf16 v96, v36, v36, v96
    v_dot2_f32_bf16 v98, v36, s84, v98
    v_dot2_f32_bf16 v96, v37, v37, v96
    v_dot2_f32_bf16 v98, v37, s84, v98
    v_dot2_f32_bf16 v96, v38, v38, v96
    v_dot2_f32_bf16 v98, v38, s84, v98
    v_dot2_f32_bf16 v96, v39, v39, v96
    v_dot2_f32_bf16 v98, v39, s84, v98
    s_waitcnt vmcnt(0)
    v_dot2_f32_bf16 v76, v40, s85, v76
    v_dot2_f32_bf16 v77, v40, s86, v77
    v_dot2_f32_bf16 v97, v40, v40, v97
    v_dot2_f32_bf16 v99, v40, s84, v99
    v_dot2_f32_bf16 v78, v41, s85, v78
    v_dot2_f32_bf16 v79, v41, s86, v79
    v_dot2_f32_bf16 v97, v41, v41, v97
    v_dot2_f32_bf16 v99, v41, s84, v99
    v_dot2_f32_bf16 v80, v42, s85, v80
    v_dot2_f32_bf16 v81, v42, s86, v81
    v_dot2_f32_bf16 v97, v42, v42, v97
    v_dot2_f32_bf16 v99, v42, s84, v99
    v_dot2_f32_bf16 v82, v43, s85, v82
    v_dot2_f32_bf16 v83, v43, s86, v83
    v_dot2_f32_bf16 v97, v43, v43, v97
    v_dot2_f32_bf16 v99, v43, s84, v99
    s_cmp_eq_u32 s89, 0
    s_cbranch_scc1 K1_NX
    s_cmp_ge_u32 s3, 540
    s_cbranch_scc1 PB_NU
    s_lshl_b32 s24, s16, 13
    s_add_u32 m0, s24, 0
    s_movk_i32 s27, 0
    buffer_load_dwordx4 v152, s[96:99], s27 offen nt lds
    s_add_u32 m0, s24, 1024
    s_movk_i32 s27, 5120
    buffer_load_dwordx4 v153, s[96:99], s27 offen nt lds
    s_add_u32 m0, s24, 2048
    s_movk_i32 s27, 10240
    buffer_load_dwordx4 v152, s[96:99], s27 offen nt lds
    s_add_u32 m0, s24, 3072
    s_movk_i32 s27, 15360
    buffer_load_dwordx4 v153, s[96:99], s27 offen nt lds
PB_NU:
    s_and_b32 s24, s16, 3
    s_lshl_b32 s24, s24, 11
K1_NX:
    s_nop 2
    v_add_f32 v100, v96, v97
    v_add_f32 v101, v98, v99
    s_nop 0
    v_add_f32_dpp v100, v100, v100 quad_perm:[1,0,3,2] row_mask:0xf bank_mask:0xf
    v_add_f32_dpp v101, v101, v101 quad_perm:[1,0,3,2] row_mask:0xf bank_mask:0xf
    s_nop 0
    v_add_f32_dpp v100, v100, v100 quad_perm:[2,3,0,1] row_mask:0xf bank_mask:0xf
    v_add_f32_dpp v101, v101, v101 quad_perm:[2,3,0,1] row_mask:0xf bank_mask:0xf
    s_nop 0
    v_add_f32_dpp v100, v100, v100 row_half_mirror row_mask:0xf bank_mask:0xf
    v_add_f32_dpp v101, v101, v101 row_half_mirror row_mask:0xf bank_mask:0xf
    v_mul_f32 v101, 0x3acccccd, v101
    v_mul_f32 v100, 0x3acccccd, v100
    v_fma_f32 v100, -v101, v101, v100
    v_max_f32 v100, 0, v100
    v_add_f32 v100, 0x3727c5ac, v100
    v_rsq_f32 v100, v100
    s_nop 0
    v_mul_f32 v105, v101, v100
    v_cndmask_b32 v102, v100, -v100, s[82:83]
    v_mov_b32_dpp v103, v100 row_ror:8 row_mask:0xf bank_mask:0xf
    v_mul_f32 v104, v102, v101
    s_nop 1
    v_add_f32_dpp v104, v105, v104 row_ror:8 row_mask:0xf bank_mask:0xf
    v_mul_f32 v104, s87, v104
    v_fma_f32 v4, v102, v44, v104
    v_fma_f32 v5, v102, v45, v104
    v_fma_f32 v6, v102, v46, v104
    v_fma_f32 v7, v102, v47, v104
    v_fma_f32 v8, v102, v48, v104
    v_fma_f32 v9, v102, v49, v104
    v_fma_f32 v10, v102, v50, v104
    v_fma_f32 v11, v102, v51, v104
    v_fmac_f32_dpp v4, v44, v103 row_ror:8 row_mask:0xf bank_mask:0xf
    v_fmac_f32_dpp v5, v45, v103 row_ror:8 row_mask:0xf bank_mask:0xf
    v_fmac_f32_dpp v6, v46, v103 row_ror:8 row_mask:0xf bank_mask:0xf
    v_fmac_f32_dpp v7, v47, v103 row_ror:8 row_mask:0xf bank_mask:0xf
    v_fmac_f32_dpp v8, v48, v103 row_ror:8 row_mask:0xf bank_mask:0xf
    v_fmac_f32_dpp v9, v49, v103 row_ror:8 row_mask:0xf bank_mask:0xf
    v_fmac_f32_dpp v10, v50, v103 row_ror:8 row_mask:0xf bank_mask:0xf
    v_fmac_f32_dpp v11, v51, v103 row_ror:8 row_mask:0xf bank_mask:0xf
    v_cvt_pk_f16_f32 v12, v4, v5
    v_cvt_pk_f16_f32 v13, v6, v7
    v_cvt_pk_f16_f32 v14, v8, v9
    v_cvt_pk_f16_f32 v15, v10, v11
    ds_write_b128 v94, v[12:15] offset:0
    v_fma_f32 v20, v102, v52, v104
    v_fma_f32 v21, v102, v53, v104
    v_fma_f32 v22, v102, v54, v104
    v_fma_f32 v23, v102, v55, v104
    v_fma_f32 v24, v102, v56, v104
    v_fma_f32 v25, v102, v57, v104
    v_fma_f32 v26, v102, v58, v104
    v_fma_f32 v27, v102, v59, v104
    v_fmac_f32_dpp v20, v52, v103 row_ror:8 row_mask:0xf bank_mask:0xf
    v_fmac_f32_dpp v21, v53, v103 row_ror:8 row_mask:0xf bank_mask:0xf
    v_fmac_f32_dpp v22, v54, v103 row_ror:8 row_mask:0xf bank_mask:0xf
    v_fmac_f32_dpp v23, v55, v103 row_ror:8 row_mask:0xf bank_mask:0xf
    v_fmac_f32_dpp v24, v56, v103 row_ror:8 row_mask:0xf bank_mask:0xf
    v_fmac_f32_dpp v25, v57, v103 row_ror:8 row_mask:0xf bank_mask:0xf
    v_fmac_f32_dpp v26, v58, v103 row_ror:8 row_mask:0xf bank_mask:0xf
    v_fmac_f32_dpp v27, v59, v103 row_ror:8 row_mask:0xf bank_mask:0xf
    v_cvt_pk_f16_f32 v28, v20, v21
    v_cvt_pk_f16_f32 v29, v22, v23
    v_cvt_pk_f16_f32 v30, v24, v25
    v_cvt_pk_f16_f32 v31, v26, v27
    ds_write_b128 v94, v[28:31] offset:2048
    v_fma_f32 v4, v102, v60, v104
    v_fma_f32 v5, v102, v61, v104
    v_fma_f32 v6, v102, v62, v104
    v_fma_f32 v7, v102, v63, v104
    v_fma_f32 v8, v102, v64, v104
    v_fma_f32 v9, v102, v65, v104
    v_fma_f32 v10, v102, v66, v104
    v_fma_f32 v11, v102, v67, v104
    v_fmac_f32_dpp v4, v60, v103 row_ror:8 row_mask:0xf bank_mask:0xf
    v_fmac_f32_dpp v5, v61, v103 row_ror:8 row_mask:0xf bank_mask:0xf
    v_fmac_f32_dpp v6, v62, v103 row_ror:8 row_mask:0xf bank_mask:0xf
    v_fmac_f32_dpp v7, v63, v103 row_ror:8 row_mask:0xf bank_mask:0xf
    v_fmac_f32_dpp v8, v64, v103 row_ror:8 row_mask:0xf bank_mask:0xf
    v_fmac_f32_dpp v9, v65, v103 row_ror:8 row_mask:0xf bank_mask:0xf
    v_fmac_f32_dpp v10, v66, v103 row_ror:8 row_mask:0xf bank_mask:0xf
    v_fmac_f32_dpp v11, v67, v103 row_ror:8 row_mask:0xf bank_mask:0xf
    v_cvt_pk_f16_f32 v12, v4, v5
    v_cvt_pk_f16_f32 v13, v6, v7
    v_cvt_pk_f16_f32 v14, v8, v9
    v_cvt_pk_f16_f32 v15, v10, v11
    ds_write_b128 v94, v[12:15] offset:4096
    v_fma_f32 v20, v102, v68, v104
    v_fma_f32 v21, v102, v69, v104
    v_fma_f32 v22, v102, v70, v104
    v_fma_f32 v23, v102, v71, v104
    v_fma_f32 v24, v102, v72, v104
    v_fma_f32 v25, v102, v73, v104
    v_fma_f32 v26, v102, v74, v104
    v_fma_f32 v27, v102, v75, v104
    v_fmac_f32_dpp v20, v68, v103 row_ror:8 row_mask:0xf bank_mask:0xf
    v_fmac_f32_dpp v21, v69, v103 row_ror:8 row_mask:0xf bank_mask:0xf
    v_fmac_f32_dpp v22, v70, v103 row_ror:8 row_mask:0xf bank_mask:0xf
    v_fmac_f32_dpp v23, v71, v103 row_ror:8 row_mask:0xf bank_mask:0xf
    v_fmac_f32_dpp v24, v72, v103 row_ror:8 row_mask:0xf bank_mask:0xf
    v_fmac_f32_dpp v25, v73, v103 row_ror:8 row_mask:0xf bank_mask:0xf
    v_fmac_f32_dpp v26, v74, v103 row_ror:8 row_mask:0xf bank_mask:0xf
    v_fmac_f32_dpp v27, v75, v103 row_ror:8 row_mask:0xf bank_mask:0xf
    v_cvt_pk_f16_f32 v28, v20, v21
    v_cvt_pk_f16_f32 v29, v22, v23
    v_cvt_pk_f16_f32 v30, v24, v25
    v_cvt_pk_f16_f32 v31, v26, v27
    ds_write_b128 v94, v[28:31] offset:6144
    v_fma_f32 v4, v102, v76, v104
    v_fma_f32 v5, v102, v77, v104
    v_fma_f32 v6, v102, v78, v104
    v_fma_f32 v7, v102, v79, v104
    v_fma_f32 v8, v102, v80, v104
    v_fma_f32 v9, v102, v81, v104
    v_fma_f32 v10, v102, v82, v104
    v_fma_f32 v11, v102, v83, v104
    v_fmac_f32_dpp v4, v76, v103 row_ror:8 row_mask:0xf bank_mask:0xf
    v_fmac_f32_dpp v5, v77, v103 row_ror:8 row_mask:0xf bank_mask:0xf
    v_fmac_f32_dpp v6, v78, v103 row_ror:8 row_mask:0xf bank_mask:0xf
    v_fmac_f32_dpp v7, v79, v103 row_ror:8 row_mask:0xf bank_mask:0xf
    v_fmac_f32_dpp v8, v80, v103 row_ror:8 row_mask:0xf bank_mask:0xf
    v_fmac_f32_dpp v9, v81, v103 row_ror:8 row_mask:0xf bank_mask:0xf
    v_fmac_f32_dpp v10, v82, v103 row_ror:8 row_mask:0xf bank_mask:0xf
    v_fmac_f32_dpp v11, v83, v103 row_ror:8 row_mask:0xf bank_mask:0xf
    v_cvt_pk_f16_f32 v12, v4, v5
    v_cvt_pk_f16_f32 v13, v6, v7
    v_cvt_pk_f16_f32 v14, v8, v9
    v_cvt_pk_f16_f32 v15, v10, v11
    ds_write_b128 v94, v[12:15] offset:8192
    s_waitcnt lgkmcnt(0)
    s_barrier
    s_cmp_eq_u32 s89, 1
    s_cbranch_scc1 PB_POST
    s_cmp_eq_u32 s88, 1
    s_cbranch_scc1 PB
    s_setprio 3
    ds_read_b128 v[4:7], v192 offset:0
    ds_read_b128 v[8:11], v192 offset:10240
    ds_read_b128 v[12:15], v192 offset:20480
    ds_read_b128 v[16:19], v192 offset:30720
    ds_read_b128 v[20:23], v193 offset:1024
    ds_read_b128 v[24:27], v193 offset:11264
    ds_read_b128 v[28:31], v193 offset:21504
    ds_read_b128 v[32:35], v193 offset:31744
    ds_read_b128 v[36:39], v192 offset:2048
    ds_read_b128 v[40:43], v192 offset:12288
    ds_read_b128 v[44:47], v192 offset:22528
    ds_read_b128 v[48:51], v192 offset:32768
    ds_read_b128 v[52:55], v193 offset:3072
    ds_read_b128 v[56:59], v193 offset:13312
    s_waitcnt lgkmcnt(13)
    v_mfma_f32_16x16x32_f16 v[200:203], v[4:7], v[128:131], 0
    ds_read_b128 v[60:63], v193 offset:23552
    s_waitcnt lgkmcnt(13)
    v_mfma_f32_16x16x32_f16 v[204:207], v[8:11], v[128:131], 0
    ds_read_b128 v[64:67], v193 offset:33792
    s_waitcnt lgkmcnt(13)
    v_mfma_f32_16x16x32_f16 v[208:211], v[12:15], v[148:151], 0
    ds_read_b128 v[68:71], v192 offset:4096
    s_waitcnt lgkmcnt(13)
    v_mfma_f32_16x16x32_f16 v[212:215], v[16:19], v[148:151], 0
    ds_read_b128 v[72:75], v192 offset:14336
    s_waitcnt lgkmcnt(13)
    v_mfma_f32_16x16x32_f16 v[200:203], v[20:23], v[132:135], v[200:203]
    ds_read_b128 v[76:79], v192 offset:24576
    s_waitcnt lgkmcnt(13)
    v_mfma_f32_16x16x32_f16 v[204:207], v[24:27], v[132:135], v[204:207]
    ds_read_b128 v[80:83], v192 offset:34816
    s_waitcnt lgkmcnt(13)
    v_mfma_f32_16x16x32_f16 v[208:211], v[28:31], v[152:155], v[208:211]
    ds_read_b128 v[4:7], v195 offset:5120
    s_waitcnt lgkmcnt(13)
    v_mfma_f32_16x16x32_f16 v[212:215], v[32:35], v[152:155], v[212:215]
    ds_read_b128 v[8:11], v195 offset:15360
    s_waitcnt lgkmcnt(13)
    v_mfma_f32_16x16x32_f16 v[200:203], v[36:39], v[136:139], v[200:203]
    ds_read_b128 v[12:15], v197 offset:5120
    s_waitcnt lgkmcnt(13)
    v_mfma_f32_16x16x32_f16 v[204:207], v[40:43], v[136:139], v[204:207]
    ds_read_b128 v[16:19], v197 offset:15360
    s_waitcnt lgkmcnt(13)
    v_mfma_f32_16x16x32_f16 v[208:211], v[44:47], v[156:159], v[208:211]
    ds_read_b128 v[20:23], v194 offset:6144
    s_waitcnt lgkmcnt(13)
    v_mfma_f32_16x16x32_f16 v[212:215], v[48:51], v[156:159], v[212:215]
    ds_read_b128 v[24:27], v194 offset:16384
    s_waitcnt lgkmcnt(13)
    v_mfma_f32_16x16x32_f16 v[200:203], v[52:55], v[140:143], v[200:203]
    ds_read_b128 v[28:31], v196 offset:6144
    s_waitcnt lgkmcnt(13)
    v_mfma_f32_16x16x32_f16 v[204:207], v[56:59], v[140:143], v[204:207]
    ds_read_b128 v[32:35], v196 offset:16384
    s_waitcnt lgkmcnt(13)
    v_mfma_f32_16x16x32_f16 v[208:211], v[60:63], v[160:163], v[208:211]
    ds_read_b128 v[36:39], v195 offset:7168
    s_waitcnt lgkmcnt(13)
    v_mfma_f32_16x16x32_f16 v[212:215], v[64:67], v[160:163], v[212:215]
    ds_read_b128 v[40:43], v195 offset:17408
    s_waitcnt lgkmcnt(13)
    v_mfma_f32_16x16x32_f16 v[200:203], v[68:71], v[144:147], v[200:203]
    ds_read_b128 v[44:47], v197 offset:7168
    s_waitcnt lgkmcnt(13)
    v_mfma_f32_16x16x32_f16 v[204:207], v[72:75], v[144:147], v[204:207]
    ds_read_b128 v[48:51], v197 offset:17408
    s_waitcnt lgkmcnt(13)
    v_mfma_f32_16x16x32_f16 v[208:211], v[76:79], v[164:167], v[208:211]
    ds_read_b128 v[52:55], v194 offset:8192
    s_waitcnt lgkmcnt(13)
    v_mfma_f32_16x16x32_f16 v[212:215], v[80:83], v[164:167], v[212:215]
    ds_read_b128 v[56:59], v194 offset:18432
    s_waitcnt lgkmcnt(13)
    v_mfma_f32_16x16x32_f16 v[216:219], v[4:7], v[128:131], 0
    ds_read_b128 v[60:63], v196 offset:8192
    s_waitcnt lgkmcnt(13)
    v_mfma_f32_16x16x32_f16 v[220:223], v[8:11], v[128:131], 0
    ds_read_b128 v[64:67], v196 offset:18432
    s_waitcnt lgkmcnt(13)
    v_mfma_f32_16x16x32_f16 v[224:227], v[12:15], v[148:151], 0
    ds_read_b128 v[68:71], v195 offset:9216
    s_waitcnt lgkmcnt(13)
    v_mfma_f32_16x16x32_f16 v[228:231], v[16:19], v[148:151], 0
    ds_read_b128 v[72:75], v195 offset:19456
    s_waitcnt lgkmcnt(13)
    v_mfma_f32_16x16x32_f16 v[216:219], v[20:23], v[132:135], v[216:219]
    ds_read_b128 v[76:79], v197 offset:9216
    s_waitcnt lgkmcnt(13)
    v_mfma_f32_16x16x32_f16 v[220:223], v[24:27], v[132:135], v[220:223]
    ds_read_b128 v[80:83], v197 offset:19456
    s_waitcnt lgkmcnt(13)
    v_mfma_f32_16x16x32_f16 v[224:227], v[28:31], v[152:155], v[224:227]
    s_waitcnt lgkmcnt(12)
    v_mfma_f32_16x16x32_f16 v[228:231], v[32:35], v[152:155], v[228:231]
    s_waitcnt lgkmcnt(11)
    v_mfma_f32_16x16x32_f16 v[216:219], v[36:39], v[136:139], v[216:219]
    s_waitcnt lgkmcnt(10)
    v_mfma_f32_16x16x32_f16 v[220:223], v[40:43], v[136:139], v[220:223]
    s_waitcnt lgkmcnt(9)
    v_mfma_f32_16x16x32_f16 v[224:227], v[44:47], v[156:159], v[224:227]
    s_waitcnt lgkmcnt(8)
    v_mfma_f32_16x16x32_f16 v[228:231], v[48:51], v[156:159], v[228:231]
    s_waitcnt lgkmcnt(7)
    v_mfma_f32_16x16x32_f16 v[216:219], v[52:55], v[140:143], v[216:219]
    s_waitcnt lgkmcnt(6)
    v_mfma_f32_16x16x32_f16 v[220:223], v[56:59], v[140:143], v[220:223]
    s_waitcnt lgkmcnt(5)
    v_mfma_f32_16x16x32_f16 v[224:227], v[60:63], v[160:163], v[224:227]
    s_waitcnt lgkmcnt(4)
    v_mfma_f32_16x16x32_f16 v[228:231], v[64:67], v[160:163], v[228:231]
    s_waitcnt lgkmcnt(3)
    v_mfma_f32_16x16x32_f16 v[216:219], v[68:71], v[144:147], v[216:219]
    s_waitcnt lgkmcnt(2)
    v_mfma_f32_16x16x32_f16 v[220:223], v[72:75], v[144:147], v[220:223]
    s_waitcnt lgkmcnt(1)
    v_mfma_f32_16x16x32_f16 v[224:227], v[76:79], v[164:167], v[224:227]
    s_waitcnt lgkmcnt(0)
    v_mfma_f32_16x16x32_f16 v[228:231], v[80:83], v[164:167], v[228:231]
    s_nop 1
    v_fmac_f32 v200, v198, v216
    v_fma_f32 v208, -v199, v216, v208
    v_fmac_f32 v201, v198, v217
    v_fma_f32 v209, -v199, v217, v209
    v_fmac_f32 v202, v198, v218
    v_fma_f32 v210, -v199, v218, v210
    v_fmac_f32 v203, v198, v219
    v_fma_f32 v211, -v199, v219, v211
    v_fmac_f32 v204, v198, v220
    v_fma_f32 v212, -v199, v220, v212
    v_fmac_f32 v205, v198, v221
    v_fma_f32 v213, -v199, v221, v213
    v_fmac_f32 v206, v198, v222
    v_fma_f32 v214, -v199, v222, v214
    v_fmac_f32 v207, v198, v223
    v_fma_f32 v215, -v199, v223, v215
    v_fmac_f32 v200, v199, v224
    v_fmac_f32 v208, v198, v224
    v_fmac_f32 v201, v199, v225
    v_fmac_f32 v209, v198, v225
    v_fmac_f32 v202, v199, v226
    v_fmac_f32 v210, v198, v226
    v_fmac_f32 v203, v199, v227
    v_fmac_f32 v211, v198, v227
    v_fmac_f32 v204, v199, v228
    v_fmac_f32 v212, v198, v228
    v_fmac_f32 v205, v199, v229
    v_fmac_f32 v213, v198, v229
    v_fmac_f32 v206, v199, v230
    v_fmac_f32 v214, v198, v230
    v_fmac_f32 v207, v199, v231
    v_fmac_f32 v215, v198, v231
    v_cvt_pk_f16_f32 v128, v200, v201
    v_cvt_pk_f16_f32 v129, v202, v203
    v_cvt_pk_f16_f32 v130, v204, v205
    v_cvt_pk_f16_f32 v131, v206, v207
    v_cvt_pk_f16_f32 v132, v208, v209
    v_cvt_pk_f16_f32 v133, v210, v211
    v_cvt_pk_f16_f32 v134, v212, v213
    v_cvt_pk_f16_f32 v135, v214, v215
    v_mfma_f32_16x16x32_f16 v[148:151], v[128:131], v[168:171], 0
    v_mfma_f32_16x16x32_f16 v[152:155], v[128:131], v[184:187], 0
    v_mfma_f32_16x16x32_f16 v[156:159], v[128:131], v[172:175], 0
    v_mfma_f32_16x16x32_f16 v[160:163], v[128:131], v[188:191], 0
    v_mfma_f32_16x16x32_f16 v[148:151], v[132:135], v[176:179], v[148:151]
    v_mfma_f32_16x16x32_f16 v[152:155], v[132:135], v[168:171], v[152:155]
    v_mfma_f32_16x16x32_f16 v[156:159], v[132:135], v[180:183], v[156:159]
    v_mfma_f32_16x16x32_f16 v[160:163], v[132:135], v[172:175], v[160:163]
    s_and_b32 s33, s31, 31
    s_cbranch_scc0 K1_REONLY
    s_nop 2
    v_cvt_pk_f16_f32 v136, v148, v149
    v_cvt_pk_f16_f32 v137, v150, v151
    v_cvt_pk_f16_f32 v138, v152, v153
    v_cvt_pk_f16_f32 v139, v154, v155
    buffer_store_dwordx4 v[136:139], v95, s[24:27], s46 offen sc0 sc1
    v_cvt_pk_f16_f32 v140, v156, v157
    v_cvt_pk_f16_f32 v141, v158, v159
    v_cvt_pk_f16_f32 v142, v160, v161
    v_cvt_pk_f16_f32 v143, v162, v163
    buffer_store_dwordx4 v[140:143], v95, s[24:27], s47 offen sc0 sc1
    s_branch UA
K1_REONLY:
    s_lshr_b32 s33, s31, 2
    s_add_u32 s46, s46, s33
    s_add_u32 s47, s47, s33
    v_cvt_pk_f16_f32 v136, v148, v149
    v_cvt_pk_f16_f32 v137, v150, v151
    buffer_store_dwordx2 v[136:137], v95, s[24:27], s46 offen sc0 sc1
    v_cvt_pk_f16_f32 v140, v156, v157
    v_cvt_pk_f16_f32 v141, v158, v159
    buffer_store_dwordx2 v[140:141], v95, s[24:27], s47 offen sc0 sc1
UA:
    s_mov_b32 s90, s38
    s_branch PB2
K1_SP2:
    s_mov_b32 s89, 0
    v_mov_b32 v96, 0
    v_mov_b32 v97, 0
    v_mov_b32 v98, 0
    v_mov_b32 v99, 0
    s_waitcnt lgkmcnt(0)
    v_mov_b32 v90, 73728
    ds_write_b128 v90, v[96:99]
    s_cmp_lt_u32 s32, 54
    s_cbranch_scc1 K1_NZ
    v_lshlrev_b32 v89, 7, v88
    v_mov_b32 v90, 1
    s_waitcnt vmcnt(0) lgkmcnt(0)
    s_barrier
    s_cmp_lg_u32 s28, 0
    s_cbranch_scc1 PB
    s_mov_b32 s90, 1
    s_cmp_lt_u32 s32, 56
    s_cbranch_scc1 PB2
    s_and_b32 s50, s32, 1
    s_lshl_b32 s50, s50, 2
    s_mov_b64 exec, 3
    buffer_store_dword v90, v89, s[20:23], s50 offen sc0 sc1
    s_mov_b64 exec, -1
    s_branch PB
K1_NZ:
    s_and_b32 s53, s28, 3
    s_lshr_b32 s54, s28, 2
    s_mul_i32 s50, s54, 20480
    v_lshrrev_b32 v91, 4, v88
    v_bfe_u32 v89, v88, 2, 2
    v_lshl_add_u32 v90, v91, 3, v89
    v_lshl_add_u32 v90, v90, 7, s50
    v_and_b32 v92, 3, v88
    v_lshl_add_u32 v90, v92, 3, v90
    v_lshrrev_b32 v89, 1, v89
    v_and_b32 v91, 1, v91
    v_lshl_or_b32 v89, v91, 1, v89
    v_xor_b32 v89, s53, v89
    v_lshl_add_u32 v124, v89, 5, v90
    s_lshl_b32 s55, s52, 2
    s_add_u32 s55, s55, s53
    s_mul_i32 s56, s55, 20480
    s_mul_i32 s57, s54, 10240
    s_add_u32 s56, s56, s57
    s_and_b32 s57, s32, 1
    s_lshl_b32 s58, s57, 10
    s_add_u32 s56, s56, s58
    s_add_u32 s56, s56, 1310720
    s_lshr_b32 s58, s55, 1
    s_lshl_b32 s58, s58, 9
    s_lshl_b32 s57, s57, 1
    s_add_u32 s57, s57, s54
    s_lshl_b32 s57, s57, 7
    s_add_u32 s58, s58, s57
    s_and_b32 s57, s55, 1
    s_lshl_b32 s57, s57, 6
    s_add_u32 s58, s58, s57
    s_add_u32 s57, s58, 5742592
    v_mov_b32 v168, 0x3f803f80
    v_mov_b32 v169, 0x3f803f80
    v_mov_b32 v170, 0x3f803f80
    v_mov_b32 v171, 0x3f803f80
    v_lshlrev_b32 v89, 2, v88
    s_waitcnt vmcnt(0) lgkmcnt(0)
    s_barrier
    ds_read_b64_tr_b16 v[128:129], v124 offset:0
    ds_read_b64_tr_b16 v[130:131], v124 offset:512
    ds_read_b64_tr_b16 v[132:133], v124 offset:4096
    ds_read_b64_tr_b16 v[134:135], v124 offset:4608
    ds_read_b64_tr_b16 v[136:137], v124 offset:8192
    ds_read_b64_tr_b16 v[138:139], v124 offset:8704
    ds_read_b64_tr_b16 v[140:141], v124 offset:12288
    ds_read_b64_tr_b16 v[142:143], v124 offset:12800
    ds_read_b64_tr_b16 v[144:145], v124 offset:16384
    ds_read_b64_tr_b16 v[146:147], v124 offset:16896
    s_waitcnt lgkmcnt(8)
    buffer_store_dwordx4 v[128:131], v120, s[24:27], s56 offen offset:0 sc0 sc1
    v_mfma_f32_16x16x32_bf16 v[176:179], v[168:171], v[128:131], 0
    s_waitcnt lgkmcnt(6)
    buffer_store_dwordx4 v[132:135], v120, s[24:27], s56 offen offset:2048 sc0 sc1
    v_mfma_f32_16x16x32_bf16 v[176:179], v[168:171], v[132:135], v[176:179]
    s_add_u32 s56, s56, 4096
    s_waitcnt lgkmcnt(4)
    buffer_store_dwordx4 v[136:139], v120, s[24:27], s56 offen offset:0 sc0 sc1
    v_mfma_f32_16x16x32_bf16 v[176:179], v[168:171], v[136:139], v[176:179]
    s_waitcnt lgkmcnt(2)
    buffer_store_dwordx4 v[140:143], v120, s[24:27], s56 offen offset:2048 sc0 sc1
    v_mfma_f32_16x16x32_bf16 v[176:179], v[168:171], v[140:143], v[176:179]
    s_add_u32 s56, s56, 4096
    s_waitcnt lgkmcnt(0)
    buffer_store_dwordx4 v[144:147], v120, s[24:27], s56 offen offset:0 sc0 sc1
    v_mfma_f32_16x16x32_bf16 v[176:179], v[168:171], v[144:147], v[176:179]
    s_mov_b64 exec, 0xffff
    s_nop 6
    buffer_store_dword v176, v89, s[24:27], s57 offen sc0 sc1
    s_mov_b64 exec, -1
    s_cmp_lg_u32 s28, 4
    s_cbranch_scc1 K1_N4
    s_waitcnt lgkmcnt(0)
    s_and_b32 s50, s2, 1
    s_lshl_b32 s50, s50, 7
    s_mov_b32 s51, 0x4000
    s_load_dwordx2 s[100:101], s[20:21], s50
ZA:
    s_waitcnt lgkmcnt(0)
    s_and_b32 s100, s100, s101
    s_cbranch_scc1 ZAD
    s_load_dwordx2 s[100:101], s[20:21], s50 glc
    s_sub_u32 s51, s51, 1
    s_cbranch_scc0 ZA
    s_waitcnt lgkmcnt(0)
ZAD:
K1_N4:
    s_waitcnt vmcnt(0) lgkmcnt(0)
    s_barrier
    s_cmp_lg_u32 s28, 4
    s_cbranch_scc1 PB
    s_mov_b32 s50, s32
    s_and_b32 s50, s50, 0
    s_lshl_b32 s50, s50, 7
    s_add_u32 s50, s50, 5819392
    v_mul_u32_u24 v89, 128, v88
    v_mov_b32 v90, 1
    s_mov_b32 exec_hi, 0
    s_mov_b32 exec_lo, 0xffffffff
    buffer_atomic_add v90, v89, s[24:27], s50 offen offset:0 sc1
    s_mov_b64 exec, -1
    s_branch PB
PB:
    s_mov_b32 s90, 0
PB2:
    s_nop 7
    s_load_dwordx2 s[44:45], s[0:1], 64
    s_load_dwordx2 s[56:57], s[0:1], 88
    s_load_dwordx2 s[8:9], s[0:1], 96
    s_load_dwordx2 s[4:5], s[0:1], 56
    s_load_dwordx2 s[48:49], s[0:1], 72
    s_load_dwordx2 s[52:53], s[0:1], 80
    v_lshrrev_b32 v253, 6, v0
    v_and_b32 v250, 63, v0
    v_readfirstlane_b32 s16, v253
    s_and_b32 s17, s2, 7
    s_lshr_b32 s18, s2, 3
    s_lshr_b32 s19, s17, 0
    s_lshl_b32 s19, s19, 2
    s_lshr_b32 s20, s18, 3
    s_add_u32 s19, s19, s20
    s_and_b32 s20, s17, 0
    s_lshl_b32 s20, s20, 3
    s_and_b32 s21, s18, 7
    s_add_u32 s20, s20, s21
    s_mov_b32 s10, 12921856
    s_mov_b32 s11, 0x20000
    s_mov_b32 s6, 3456
    s_mov_b32 s7, 0x20000
    s_mov_b32 s50, 1280
    s_mov_b32 s51, 0x20000
    s_mov_b32 s54, 2621440
    s_mov_b32 s55, 0x20000
    s_mov_b32 s46, 2211840
    s_mov_b32 s47, 0x20000
    v_lshlrev_b32 v1, 4, v250
    v_and_b32 v251, 15, v250
    v_lshrrev_b32 v252, 4, v250
    s_waitcnt lgkmcnt(0)
    v_mov_b32 v148, 0
    v_mov_b32 v149, 0
    v_mov_b32 v150, 0
    v_mov_b32 v151, 0
    v_mov_b32 v152, 0
    v_mov_b32 v153, 0
    v_mov_b32 v154, 0
    v_mov_b32 v155, 0
    v_mov_b32 v156, 0
    v_mov_b32 v157, 0
    v_mov_b32 v158, 0
    v_mov_b32 v159, 0
    s_mov_b64 s[96:97], s[44:45]
    s_mov_b64 s[98:99], s[46:47]
    s_mov_b32 s3, 540
    s_cmp_lt_u32 s16, 4
    s_cbranch_scc1 PB_LO
    s_and_b32 s24, s16, 1
    s_and_b32 s26, s19, 1
    s_cselect_b32 s25, -1024, 16
    s_lshl_b32 s26, s26, 1
    s_add_u32 s26, s26, s24
    s_lshl_b32 s26, s26, 9
    s_lshr_b32 s27, s19, 1
    s_cselect_b32 s25, s27, s25
    s_add_u32 s25, s25, s26
    s_cmp_ge_u32 s16, 6
    s_cselect_b64 s[38:39], -1, 0
    v_lshrrev_b32 v164, 3, v250
    v_lshl_add_u32 v165, v164, 5, s25
    v_sub_u32 v166, 0x800, v165
    v_cmp_eq_u32 vcc, 0, v165
    v_cndmask_b32 v165, v165, v166, s[38:39]
    v_lshrrev_b32 v166, 1, v165
    v_cndmask_b32 v165, v165, v166, vcc
    v_mul_u32_u24 v165, 1280, v165
    v_lshrrev_b32 v164, 1, v164
    v_and_b32 v166, 7, v250
    v_xor_b32 v164, v164, v166
    v_lshl_add_u32 v154, v164, 4, v165
    v_lshrrev_b32 v164, 3, v250
    v_add_u32 v164, 8, v164
    v_lshl_add_u32 v165, v164, 5, s25
    v_sub_u32 v166, 0x800, v165
    v_cmp_eq_u32 vcc, 0, v165
    v_cndmask_b32 v165, v165, v166, s[38:39]
    v_lshrrev_b32 v166, 1, v165
    v_cndmask_b32 v165, v165, v166, vcc
    v_mul_u32_u24 v165, 1280, v165
    v_lshrrev_b32 v164, 1, v164
    v_and_b32 v166, 7, v250
    v_xor_b32 v164, v164, v166
    v_lshl_add_u32 v155, v164, 4, v165
    s_mul_i32 s3, s2, 3
    s_add_u32 s3, s3, s16
    s_sub_u32 s3, s3, 5
    s_cmp_eq_u32 s16, 4
    s_cselect_b32 s3, 540, s3
    s_cmp_ge_u32 s3, 540
    s_cbranch_scc1 PB_X
    s_lshl_b32 s24, s16, 13
    s_mul_i32 s25, s3, 6554
    s_lshr_b32 s25, s25, 16
    s_mul_i32 s26, s25, 10
    s_sub_u32 s26, s3, s26
    v_lshrrev_b32 v253, 3, v250
    v_and_b32 v254, 7, v250
    v_and_b32 v255, 2, v253
    v_xor_b32 v254, v254, v255
    v_lshlrev_b32 v254, 4, v254
    v_and_b32 v255, 4, v253
    v_mul_u32_u24 v255, 3, v255
    v_add_u32 v255, v255, v253
    v_mul_u32_u24 v255, 1280, v255
    v_add_u32 v253, v255, v254
    v_xor_b32 v254, 64, v254
    v_add_u32 v254, v255, v254
    s_mul_i32 s27, s25, 40960
    s_lshl_b32 s28, s26, 7
    s_add_u32 s27, s27, s28
    v_add_u32 v152, s27, v253
    v_add_u32 v153, s27, v254
    s_mul_i32 s25, s25, 5120
    s_add_u32 s25, s25, 3522560
    s_lshl_b32 s26, s26, 2
    s_add_u32 s27, s26, 0
    s_mul_i32 s28, s27, 52
    s_lshr_b32 s28, s28, 8
    s_mul_i32 s28, s28, 271360
    s_lshl_b32 s27, s27, 10
    s_add_u32 s27, s27, s28
    v_mov_b32 v156, s27
    v_add3_u32 v156, v156, v1, s25
    s_add_u32 s27, s26, 1
    s_mul_i32 s28, s27, 52
    s_lshr_b32 s28, s28, 8
    s_mul_i32 s28, s28, 271360
    s_lshl_b32 s27, s27, 10
    s_add_u32 s27, s27, s28
    v_mov_b32 v157, s27
    v_add3_u32 v157, v157, v1, s25
    s_add_u32 s27, s26, 2
    s_mul_i32 s28, s27, 52
    s_lshr_b32 s28, s28, 8
    s_mul_i32 s28, s28, 271360
    s_lshl_b32 s27, s27, 10
    s_add_u32 s27, s27, s28
    v_mov_b32 v158, s27
    v_add3_u32 v158, v158, v1, s25
    s_add_u32 s27, s26, 3
    s_mul_i32 s28, s27, 52
    s_lshr_b32 s28, s28, 8
    s_mul_i32 s28, s28, 271360
    s_lshl_b32 s27, s27, 10
    s_add_u32 s27, s27, s28
    v_mov_b32 v159, s27
    v_add3_u32 v159, v159, v1, s25
    v_bfe_u32 v253, v250, 2, 2
    v_lshl_add_u32 v254, v252, 3, v253
    v_lshl_add_u32 v254, v254, 7, s24
    v_and_b32 v255, 3, v250
    v_lshl_add_u32 v254, v255, 3, v254
    v_lshrrev_b32 v253, 1, v253
    v_and_b32 v255, 1, v252
    v_lshl_or_b32 v253, v255, 1, v253
    v_xor_b32 v148, 0, v253
    v_lshl_add_u32 v148, v148, 5, v254
    v_xor_b32 v149, 1, v253
    v_lshl_add_u32 v149, v149, 5, v254
    v_xor_b32 v150, 2, v253
    v_lshl_add_u32 v150, v150, 5, v254
    v_xor_b32 v151, 3, v253
    v_lshl_add_u32 v151, v151, 5, v254
PB_X:
PB_LO:
    s_cmp_eq_u32 s89, 1
    s_cbranch_scc1 K1_XLD
    s_cmp_lt_u32 s16, 4
    s_cbranch_scc1 PB_SET
    s_and_b32 s24, s16, 3
    s_lshl_b32 s24, s24, 11
PB_POST:
    s_and_b32 s24, s16, 3
    s_lshl_b32 s24, s24, 11
    s_add_u32 m0, s24, 81920
    s_movk_i32 s27, 0
    buffer_load_dwordx4 v154, s[12:15], s27 offen lds
    s_add_u32 m0, s24, 82944
    s_movk_i32 s27, 0
    buffer_load_dwordx4 v155, s[12:15], s27 offen lds
    s_add_u32 m0, s24, 90112
    s_movk_i32 s27, 128
    buffer_load_dwordx4 v154, s[12:15], s27 offen lds
    s_add_u32 m0, s24, 91136
    s_movk_i32 s27, 128
    buffer_load_dwordx4 v155, s[12:15], s27 offen lds
    s_add_u32 m0, s24, 98304
    s_movk_i32 s27, 256
    buffer_load_dwordx4 v154, s[12:15], s27 offen lds
    s_add_u32 m0, s24, 99328
    s_movk_i32 s27, 256
    buffer_load_dwordx4 v155, s[12:15], s27 offen lds
    s_add_u32 m0, s24, 106496
    s_movk_i32 s27, 384
    buffer_load_dwordx4 v154, s[12:15], s27 offen lds
    s_add_u32 m0, s24, 107520
    s_movk_i32 s27, 384
    buffer_load_dwordx4 v155, s[12:15], s27 offen lds
    s_add_u32 m0, s24, 114688
    s_movk_i32 s27, 512
    buffer_load_dwordx4 v154, s[12:15], s27 offen lds
    s_add_u32 m0, s24, 115712
    s_movk_i32 s27, 512
    buffer_load_dwordx4 v155, s[12:15], s27 offen lds
    s_add_u32 m0, s24, 122880
    s_movk_i32 s27, 640
    buffer_load_dwordx4 v154, s[12:15], s27 offen lds
    s_add_u32 m0, s24, 123904
    s_movk_i32 s27, 640
    buffer_load_dwordx4 v155, s[12:15], s27 offen lds
    s_add_u32 m0, s24, 131072
    s_movk_i32 s27, 768
    buffer_load_dwordx4 v154, s[12:15], s27 offen lds
    s_add_u32 m0, s24, 132096
    s_movk_i32 s27, 768
    buffer_load_dwordx4 v155, s[12:15], s27 offen lds
    s_cmp_lg_u32 s16, 4
    s_cbranch_scc1 PB_SET
    s_waitcnt lgkmcnt(0)
    s_and_b32 s40, s2, 1
    s_lshl_b32 s40, s40, 7
    s_mov_b32 s41, 0x4000
    s_load_dwordx2 s[100:101], s[56:57], s40
ZB:
    s_waitcnt lgkmcnt(0)
    s_and_b32 s100, s100, s101
    s_cbranch_scc1 ZBD
    s_load_dwordx2 s[100:101], s[56:57], s40 glc
    s_sub_u32 s41, s41, 1
    s_cbranch_scc0 ZB
    s_waitcnt lgkmcnt(0)
ZBD:
    v_mov_b32 v164, 73728
    v_mov_b32 v165, 1
    ds_write_b32 v164, v165 offset:4
PB_SET:
    s_mul_i32 s44, s20, 7
    s_cmp_eq_u32 s20, 7
    s_subb_u32 s44, s44, 1
    s_add_u32 s44, s44, s16
    s_lshr_b32 s45, s20, 1
    s_add_u32 s45, s45, s16
    s_cmp_eq_u32 s45, 10
    s_cselect_b32 s44, 0xc000, s44
    s_cmp_eq_u32 s16, 0
    s_cselect_b32 s44, 0xc000, s44
    s_mul_i32 s46, s44, 40960
    s_add_u32 s46, s46, 1310720
    s_mov_b32 s47, s46
    v_add_u32 v2, 20480, v1
    v_add_u32 v3, 40960, v1
    s_and_b32 s32, s16, 1
    s_bfe_u32 s31, s16, 0x10001
    s_lshr_b32 s30, s16, 2
    s_xor_b32 s30, s30, 1
    s_lshr_b32 s21, s19, 1
    s_sub_u32 s22, 32, s21
    s_cmp_eq_u32 s32, 0
    s_cselect_b32 s22, s21, s22
    s_cselect_b64 s[28:29], 0, -1
    s_cmp_eq_u32 s19, 0
    s_cselect_b32 s22, 16, s22
    s_cmp_eq_u32 s19, 1
    s_cselect_b32 s22, 0, s22
    s_mul_i32 s22, s22, 40960
    s_lshl_b32 s23, s30, 1
    s_add_u32 s23, s23, s31
    s_cmp_eq_u32 s23, 0
    s_cselect_b64 s[42:43], 0xffff, 0
    s_lshl_b32 s33, s23, 12
    s_add_u32 s22, s22, s33
    s_and_b32 s33, s19, 1
    s_lshl_b32 s33, s33, 5
    s_cmp_eq_u32 s19, 1
    s_cselect_b32 s33, 0, s33
    s_cselect_b32 s34, 64, 63
    s_mov_b64 s[40:41], 0xffff
    v_lshlrev_b32 v249, 1, v252
    v_cvt_f32_u32 v249, v249
    s_lshl_b32 s58, s23, 11
    s_mul_i32 s59, s32, 40960
    s_add_u32 s59, s59, s58
    s_add_u32 s59, s59, 1024
    s_xor_b32 s35, s32, 1
    s_mul_i32 s35, s35, 40960
    s_add_u32 s58, s58, s35
    v_add_u32 v248, s33, v251
    v_sub_u32 v254, s34, v248
    v_cmp_eq_u32 s[36:37], 64, v254
    s_nop 1
    v_cndmask_b32 v254, v254, 32, s[36:37]
    v_cndmask_b32 v248, v248, v254, s[28:29]
    v_cvt_f32_u32 v254, v248
    v_mul_f32 v254, 0x3c800000, v254
    v_mul_f32 v255, v254, v249
    v_mov_b32 v164, v255
    v_fmamk_f32 v165, v254, 0x3f800000, v255
    v_fmamk_f32 v166, v254, 0x41000000, v255
    v_fmamk_f32 v167, v254, 0x41100000, v255
    v_fmamk_f32 v168, v254, 0x41800000, v255
    v_fmamk_f32 v169, v254, 0x41880000, v255
    v_fmamk_f32 v170, v254, 0x41c00000, v255
    v_fmamk_f32 v171, v254, 0x41c80000, v255
    v_cos_f32 v172, v164
    v_sin_f32 v180, v164
    v_cos_f32 v173, v165
    v_sin_f32 v181, v165
    v_cos_f32 v174, v166
    v_sin_f32 v182, v166
    v_cos_f32 v175, v167
    v_sin_f32 v183, v167
    v_cos_f32 v176, v168
    v_sin_f32 v184, v168
    v_cos_f32 v177, v169
    v_sin_f32 v185, v169
    v_cos_f32 v178, v170
    v_sin_f32 v186, v170
    v_cos_f32 v179, v171
    v_sin_f32 v187, v171
    v_cvt_pk_f16_f32 v228, v172, v180
    v_cvt_pk_f16_f32 v229, v173, v181
    v_cvt_pk_f16_f32 v230, v174, v182
    v_cvt_pk_f16_f32 v231, v175, v183
    v_cvt_pk_f16_f32 v232, v176, v184
    v_cvt_pk_f16_f32 v233, v177, v185
    v_cvt_pk_f16_f32 v234, v178, v186
    v_cvt_pk_f16_f32 v235, v179, v187
    v_lshlrev_b32 v248, 31, v248
    v_or_b32 v248, 0x38003800, v248
    v_cndmask_b32 v228, v228, v248, s[40:41]
    s_cmp_lt_u32 s16, 4
    s_cbranch_scc1 HE_N
    s_and_b32 s24, s16, 3
    s_lshl_b32 s24, s24, 11
    s_add_u32 m0, s24, 139264
    s_movk_i32 s27, 896
    buffer_load_dwordx4 v154, s[12:15], s27 offen lds
    s_add_u32 m0, s24, 140288
    s_movk_i32 s27, 896
    buffer_load_dwordx4 v155, s[12:15], s27 offen lds
    s_add_u32 m0, s24, 147456
    s_movk_i32 s27, 1024
    buffer_load_dwordx4 v154, s[12:15], s27 offen lds
    s_add_u32 m0, s24, 148480
    s_movk_i32 s27, 1024
    buffer_load_dwordx4 v155, s[12:15], s27 offen lds
    s_add_u32 m0, s24, 155648
    s_movk_i32 s27, 1152
    buffer_load_dwordx4 v154, s[12:15], s27 offen lds
    s_add_u32 m0, s24, 156672
    s_movk_i32 s27, 1152
    buffer_load_dwordx4 v155, s[12:15], s27 offen lds
    s_cmp_lg_u32 s16, 4
    s_cbranch_scc1 HO_W
    s_waitcnt lgkmcnt(0)
    s_and_b32 s40, s19, 31
    s_mul_i32 s40, s40, 1
    s_and_b32 s41, s16, 0
    s_add_u32 s40, s40, s41
    s_lshl_b32 s40, s40, 7
    s_add_u32 s40, s40, 5819392
    s_mov_b32 s41, 0x8000
HO_G0:
    s_load_dword s26, s[8:9], s40 glc
    s_waitcnt lgkmcnt(0)
    s_sub_u32 s41, s41, 1
    s_cbranch_scc1 HO_G0D
    s_cmp_lg_u32 s26, 54
    s_cbranch_scc1 HO_G0
HO_G0D:
    v_mov_b32 v164, 73728
    v_mov_b32 v165, 1
    ds_write_b32 v164, v165 offset:8
HO_W:
    v_mov_b32 v164, 73728
HO_S0:
    ds_read_b32 v165, v164 offset:8
    s_waitcnt lgkmcnt(0)
    v_cmp_ne_u32 vcc, 1, v165
    s_cbranch_vccnz HO_S0
    s_lshl_b32 s40, s44, 9
    s_add_u32 s40, s40, 5742592
    v_and_b32 v208, 0x1ff, v1
    buffer_load_dwordx4 v[196:199], v208, s[8:11], s40 offen
    s_lshl_b32 s40, s44, 6
    v_lshlrev_b32 v208, 3, v252
    buffer_load_dwordx2 v[104:105], v208, s[4:7], s40 offen
    buffer_load_dwordx2 v[106:107], v208, s[4:7], s40 offen offset:32
    s_add_u32 s47, s46, 0
    buffer_load_dwordx4 v[4:7], v1, s[8:11], s47 offen offset:0
    buffer_load_dwordx4 v[8:11], v2, s[8:11], s47 offen offset:0
    buffer_load_dwordx4 v[12:15], v1, s[8:11], s47 offen offset:1024
    buffer_load_dwordx4 v[16:19], v2, s[8:11], s47 offen offset:1024
    buffer_load_dwordx4 v[20:23], v1, s[8:11], s47 offen offset:2048
    buffer_load_dwordx4 v[24:27], v2, s[8:11], s47 offen offset:2048
    buffer_load_dwordx4 v[28:31], v1, s[8:11], s47 offen offset:3072
    buffer_load_dwordx4 v[32:35], v2, s[8:11], s47 offen offset:3072
    s_add_u32 s47, s46, 4096
    buffer_load_dwordx4 v[36:39], v1, s[8:11], s47 offen offset:0
    buffer_load_dwordx4 v[40:43], v2, s[8:11], s47 offen offset:0
    s_mov_b64 s[40:41], 0xffff
HE_N:
    v_add_u32 v248, s33, v251
    v_add_u32 v248, 16, v248
    v_sub_u32 v254, s34, v248
    v_cndmask_b32 v248, v248, v254, s[28:29]
    v_cvt_f32_u32 v254, v248
    v_mul_f32 v254, 0x3c800000, v254
    v_mul_f32 v255, v254, v249
    v_mov_b32 v164, v255
    v_fmamk_f32 v165, v254, 0x3f800000, v255
    v_fmamk_f32 v166, v254, 0x41000000, v255
    v_fmamk_f32 v167, v254, 0x41100000, v255
    v_fmamk_f32 v168, v254, 0x41800000, v255
    v_fmamk_f32 v169, v254, 0x41880000, v255
    v_fmamk_f32 v170, v254, 0x41c00000, v255
    v_fmamk_f32 v171, v254, 0x41c80000, v255
    v_cos_f32 v172, v164
    v_sin_f32 v180, v164
    v_cos_f32 v173, v165
    v_sin_f32 v181, v165
    v_cos_f32 v174, v166
    v_sin_f32 v182, v166
    v_cos_f32 v175, v167
    v_sin_f32 v183, v167
    v_cos_f32 v176, v168
    v_sin_f32 v184, v168
    v_cos_f32 v177, v169
    v_sin_f32 v185, v169
    v_cos_f32 v178, v170
    v_sin_f32 v186, v170
    v_cos_f32 v179, v171
    v_sin_f32 v187, v171
    v_cvt_pk_f16_f32 v108, v172, v180
    v_cvt_pk_f16_f32 v109, v173, v181
    v_cvt_pk_f16_f32 v110, v174, v182
    v_cvt_pk_f16_f32 v111, v175, v183
    v_cvt_pk_f16_f32 v112, v176, v184
    v_cvt_pk_f16_f32 v113, v177, v185
    v_cvt_pk_f16_f32 v114, v178, v186
    v_cvt_pk_f16_f32 v115, v179, v187
    v_lshlrev_b32 v248, 31, v248
    v_or_b32 v248, 0x38003800, v248
    v_cndmask_b32 v108, v108, v248, s[40:41]
    s_cmp_eq_u32 s90, 0
    s_cbranch_scc1 UA_N
    v_mov_b32 v164, 73728
    v_mov_b32 v165, 1
    s_waitcnt vmcnt(0)
    s_mov_b64 exec, 1
    ds_add_rtn_u32 v166, v164, v165
    s_waitcnt lgkmcnt(0)
    s_mov_b64 exec, -1
    v_readfirstlane_b32 s40, v166
    s_nop 0
    s_add_u32 s40, s40, 1
    s_cmp_lg_u32 s40, s90
    s_cbranch_scc1 UA_N
    v_mov_b32 v164, 73728
UA_Z:
    ds_read_b32 v165, v164 offset:4
    s_waitcnt lgkmcnt(0)
    v_cmp_ne_u32 vcc, 1, v165
    s_cbranch_vccnz UA_Z
    s_mov_b32 s40, s18
    s_and_b32 s40, s40, 3
    s_lshl_b32 s40, s40, 7
    s_add_u32 s40, s40, 5823488
    v_mul_u32_u24 v164, 512, v250
    v_mov_b32 v165, 1
    s_mov_b32 exec_hi, 0
    s_mov_b32 exec_lo, 0xffffffff
    buffer_atomic_add v165, v164, s[8:11], s40 offen offset:0 sc1
    s_mov_b64 exec, -1
UA_N:
    s_mov_b64 s[40:41], 0xffff
    v_bfe_u32 v253, v250, 3, 1
    v_lshl_add_u32 v253, v252, 1, v253
    v_lshlrev_b32 v253, 6, v253
    v_and_b32 v254, 3, v250
    v_lshl_add_u32 v253, v254, 4, v253
    v_bfe_u32 v254, v250, 2, 1
    v_lshl_add_u32 v253, v254, 3, v253
    v_add_u32 v236, s58, v253
    v_add_u32 v237, s59, v253
    s_lshl_b32 s33, s32, 1
    s_xor_b32 s34, s33, 2
    v_mov_b32 v253, s34
    v_mov_b32 v254, s33
    v_cndmask_b32 v253, v253, v254, s[36:37]
    s_lshl_b32 s35, s23, 11
    s_mul_i32 s38, s34, 20480
    s_add_u32 s38, s38, s35
    v_add_u32 v245, s38, v1
    s_add_u32 s35, s35, 1024
    v_xor_b32 v254, 2, v253
    v_mul_u32_u24 v254, 20480, v254
    v_add3_u32 v246, v254, v1, s35
    s_mul_i32 s38, s33, 20480
    s_add_u32 s38, s38, s35
    s_add_u32 s38, s38, 20480
    v_add_u32 v247, s38, v1
    v_lshrrev_b32 v254, 1, v251
    s_lshl_b32 s35, s31, 2
    v_add_u32 v255, s35, v252
    v_xor_b32 v240, v255, v254
    v_xor_b32 v248, 7, v240
    v_lshlrev_b32 v248, 4, v248
    v_sub_u32 v255, 8, v255
    v_and_b32 v249, 7, v255
    v_xor_b32 v249, v249, v254
    v_lshlrev_b32 v249, 4, v249
    v_lshrrev_b32 v255, 3, v255
    v_lshl_add_u32 v249, v255, 13, v249
    s_lshl_b32 s38, s30, 13
    s_lshl_b32 s35, s33, 11
    s_add_u32 s35, s35, s38
    s_add_u32 s35, s35, 81920
    v_lshl_add_u32 v254, v251, 7, s35
    v_lshl_add_u32 v240, v240, 4, v254
    s_sub_u32 s39, 122880, s38
    v_lshl_add_u32 v253, v253, 4, v251
    v_lshl_add_u32 v253, v253, 7, s39
    v_add_u32 v241, v253, v248
    v_add_u32 v243, v253, v249
    s_lshl_b32 s35, s34, 11
    s_add_u32 s35, s35, s39
    s_add_u32 s35, s35, 2048
    v_lshl_add_u32 v253, v251, 7, s35
    v_add_u32 v242, v253, v248
    v_add_u32 v244, v253, v249
    v_mov_b32 v253, 40960
    v_cndmask_b32 v253, 0, v253, s[42:43]
    v_sub_u32 v254, v243, v253
    v_sub_u32 v255, v244, v253
    s_cmp_lt_u32 s16, 4
    s_cbranch_scc1 HO_LO
    s_cmp_eq_u32 s16, 0
    s_cselect_b64 s[24:25], -1, 0
    s_cmp_eq_u32 s16, 7
    s_cselect_b64 s[26:27], -1, 0
    s_min_u32 s40, s20, 5
    v_min_u32 v164, 6, v250
    s_and_b32 s41, s19, 3
    s_mul_i32 s41, s41, 0
    s_cmp_ge_u32 s41, 14
    s_cselect_b32 s21, 14, 0
    s_sub_u32 s41, s41, s21
    s_cmp_ge_u32 s41, 7
    s_cselect_b32 s21, 7, 0
    s_sub_u32 s41, s41, s21
    v_add3_u32 v165, v164, s41, -1
    v_subrev_u32 v167, 7, v165
    v_min_u32 v165, v165, v167
    v_add3_u32 v165, v165, s20, 1
    v_and_b32 v165, 7, v165
    v_add_u32 v166, s40, v164
    v_subrev_u32 v167, 6, v166
    v_min_u32 v166, v166, v167
    v_cndmask_b32 v165, v165, v166, s[26:27]
    s_cmp_eq_u32 s41, 0
    s_cselect_b32 s41, 7, s41
    s_add_u32 s40, s20, s41
    s_and_b32 s40, s40, 7
    v_mov_b32 v166, s40
    v_cndmask_b32 v165, v165, v166, s[24:25]
    v_mov_b32 v166, s16
    v_cndmask_b32 v164, v166, v164, s[24:25]
    v_mul_u32_u24 v166, 7, v165
    v_min_u32 v166, 48, v166
    v_add3_u32 v166, v166, v164, -1
    s_nop 0
    v_readlane_b32 s93, v166, 1
    v_readlane_b32 s94, v166, 2
    v_readlane_b32 s95, v166, 3
    v_readlane_b32 s96, v166, 4
    v_readlane_b32 s97, v166, 5
    v_readlane_b32 s98, v166, 6
    s_mov_b32 s92, s44
    s_cmp_lt_u32 s20, 6
    s_cselect_b32 s41, s16, 0
    s_cmp_eq_u32 s41, 7
    s_cselect_b32 s98, 0xc000, s98
    s_mul_i32 s100, s20, 276480
    s_add_u32 s100, s100, 3522560
    s_mul_i32 s101, s19, 221184
    s_add_u32 s101, s101, 5843968
    s_lshl_b32 s99, s19, 10
    s_add_u32 s99, s99, 5770240
    s_lshl_b32 s40, s40, 7
    s_add_u32 s40, s40, 32
    s_lshl_b32 s90, s16, 7
    s_cmp_eq_u32 s16, 0
    s_cselect_b32 s90, s40, s90
    s_add_u32 s90, s90, s99
    s_lshl_b32 s91, s16, 7
    s_lshl_b32 s40, s20, 2
    s_add_u32 s91, s91, s40
    s_lshl_b32 s17, s20, 7
    s_lshl_b32 s40, s16, 2
    s_add_u32 s17, s17, s40
    s_add_u32 s17, s17, 32
    s_waitcnt vmcnt(13)
    s_cmp_ge_u32 s3, 540
    s_cbranch_scc1 HO_NS
    ds_read_b64_tr_b16 v[164:165], v148 offset:0
    ds_read_b64_tr_b16 v[166:167], v148 offset:512
    ds_read_b64_tr_b16 v[168:169], v149 offset:0
    ds_read_b64_tr_b16 v[170:171], v149 offset:512
    ds_read_b64_tr_b16 v[172:173], v150 offset:0
    ds_read_b64_tr_b16 v[174:175], v150 offset:512
    ds_read_b64_tr_b16 v[176:177], v151 offset:0
    ds_read_b64_tr_b16 v[178:179], v151 offset:512
    s_waitcnt lgkmcnt(6)
    buffer_store_dwordx4 v[164:167], v156, s[8:11], 0 offen sc0 sc1
    s_waitcnt lgkmcnt(4)
    buffer_store_dwordx4 v[168:171], v157, s[8:11], 0 offen sc0 sc1
    s_waitcnt lgkmcnt(2)
    buffer_store_dwordx4 v[172:175], v158, s[8:11], 0 offen sc0 sc1
    s_waitcnt lgkmcnt(0)
    buffer_store_dwordx4 v[176:179], v159, s[8:11], 0 offen sc0 sc1
HO_NS:
    s_waitcnt vmcnt(12)
    v_add_f32_dpp v196, v196, v196 row_ror:8 row_mask:0xf bank_mask:0xf
    v_add_f32_dpp v197, v197, v197 row_ror:8 row_mask:0xf bank_mask:0xf
    v_add_f32_dpp v198, v198, v198 row_ror:8 row_mask:0xf bank_mask:0xf
    v_add_f32_dpp v199, v199, v199 row_ror:8 row_mask:0xf bank_mask:0xf
    v_mov_b32 v200, v196
    v_mov_b32 v201, v197
    v_mov_b32 v202, v198
    v_mov_b32 v203, v199
    v_permlane16_swap_b32 v196, v200
    v_permlane16_swap_b32 v197, v201
    v_permlane16_swap_b32 v198, v202
    v_permlane16_swap_b32 v199, v203
    v_add_f32 v100, v196, v200
    v_add_f32 v101, v197, v201
    v_add_f32 v102, v198, v202
    v_add_f32 v103, v199, v203
    buffer_load_dwordx4 v[44:47], v1, s[8:11], s47 offen offset:1024
    buffer_load_dwordx4 v[48:51], v2, s[8:11], s47 offen offset:1024
    buffer_load_dwordx4 v[52:55], v1, s[8:11], s47 offen offset:2048
    buffer_load_dwordx4 v[56:59], v2, s[8:11], s47 offen offset:2048
    buffer_load_dwordx4 v[60:63], v1, s[8:11], s47 offen offset:3072
    buffer_load_dwordx4 v[64:67], v2, s[8:11], s47 offen offset:3072
    s_add_u32 s47, s46, 8192
    buffer_load_dwordx4 v[68:71], v1, s[8:11], s47 offen offset:0
    buffer_load_dwordx4 v[72:75], v2, s[8:11], s47 offen offset:0
    s_setprio 1
    s_waitcnt lgkmcnt(0)
    s_barrier
    s_add_u32 m0, s58, 16384
    s_add_u32 s27, s22, 32768
    buffer_load_dwordx4 v1, s[8:11], s27 offen lds
    s_add_u32 m0, s58, 36864
    s_add_u32 s27, s22, 33792
    buffer_load_dwordx4 v1, s[8:11], s27 offen lds
    s_add_u32 m0, s59, 16384
    s_add_u32 s27, s22, 34816
    buffer_load_dwordx4 v1, s[8:11], s27 offen lds
    s_add_u32 m0, s59, 36864
    s_add_u32 s27, s22, 35840
    buffer_load_dwordx4 v1, s[8:11], s27 offen lds
    s_add_u32 m0, s58, 0
    s_add_u32 s27, s22, 0
    buffer_load_dwordx4 v1, s[8:11], s27 offen lds
    s_add_u32 m0, s58, 20480
    s_add_u32 s27, s22, 1024
    buffer_load_dwordx4 v1, s[8:11], s27 offen lds
    s_add_u32 m0, s59, 0
    s_add_u32 s27, s22, 2048
    buffer_load_dwordx4 v1, s[8:11], s27 offen lds
    s_add_u32 m0, s59, 20480
    s_add_u32 s27, s22, 3072
    buffer_load_dwordx4 v1, s[8:11], s27 offen lds
    s_add_u32 m0, s58, 8192
    s_add_u32 s27, s22, 16384
    buffer_load_dwordx4 v1, s[8:11], s27 offen lds
    s_add_u32 m0, s58, 28672
    s_add_u32 s27, s22, 17408
    buffer_load_dwordx4 v1, s[8:11], s27 offen lds
    s_add_u32 m0, s59, 8192
    s_add_u32 s27, s22, 18432
    buffer_load_dwordx4 v1, s[8:11], s27 offen lds
    s_add_u32 m0, s59, 28672
    s_add_u32 s27, s22, 19456
    buffer_load_dwordx4 v1, s[8:11], s27 offen lds
    ds_read_b128 v[212:215], v240 offset:32768
    ds_read_b128 v[216:219], v241 offset:0
    ds_read_b32 v248, v243 offset:0
    ds_read_b128 v[220:223], v240 offset:34816
    ds_read_b128 v[224:227], v242 offset:0
    ds_read_b32 v249, v244 offset:0
    s_waitcnt vmcnt(8)
    ds_read_b64_tr_b16 v[116:117], v236 offset:16384
    ds_read_b64_tr_b16 v[118:119], v236 offset:16896
    ds_read_b64_tr_b16 v[120:121], v236 offset:36864
    ds_read_b64_tr_b16 v[122:123], v236 offset:37376
    ds_read_b64_tr_b16 v[124:125], v237 offset:16384
    ds_read_b64_tr_b16 v[126:127], v237 offset:16896
    ds_read_b64_tr_b16 v[128:129], v237 offset:36864
    ds_read_b64_tr_b16 v[130:131], v237 offset:37376
    s_waitcnt lgkmcnt(13)
    v_lshlrev_b32 v164, 16, v212
    v_and_b32 v168, 0xffff0000, v212
    v_lshlrev_b32 v165, 16, v213
    v_and_b32 v169, 0xffff0000, v213
    v_lshlrev_b32 v166, 16, v214
    v_and_b32 v170, 0xffff0000, v214
    v_lshlrev_b32 v167, 16, v215
    v_and_b32 v171, 0xffff0000, v215
    s_waitcnt lgkmcnt(12)
    v_and_b32 v179, 0xffff0000, v216
    v_lshlrev_b32 v175, 16, v217
    v_and_b32 v178, 0xffff0000, v217
    v_lshlrev_b32 v174, 16, v218
    v_and_b32 v177, 0xffff0000, v218
    v_lshlrev_b32 v173, 16, v219
    v_and_b32 v176, 0xffff0000, v219
    s_waitcnt lgkmcnt(11)
    v_lshlrev_b32 v172, 16, v248
    s_waitcnt lgkmcnt(6)
    v_mfma_f32_16x16x32_f16 v[164:167], v[116:119], v[228:231], v[164:167]
    v_lshlrev_b32 v180, 16, v220
    v_and_b32 v184, 0xffff0000, v220
    s_waitcnt lgkmcnt(2)
    v_mfma_f32_16x16x32_f16 v[168:171], v[124:127], v[228:231], v[168:171]
    v_lshlrev_b32 v181, 16, v221
    v_and_b32 v185, 0xffff0000, v221
    v_mfma_f32_16x16x32_f16 v[172:175], v[116:119], v[228:231], v[172:175]
    v_lshlrev_b32 v182, 16, v222
    v_and_b32 v186, 0xffff0000, v222
    v_mfma_f32_16x16x32_f16 v[176:179], v[124:127], v[228:231], v[176:179]
    v_lshlrev_b32 v183, 16, v223
    v_and_b32 v187, 0xffff0000, v223
    v_mfma_f32_16x16x32_f16 v[164:167], v[120:123], v[232:235], v[164:167]
    v_and_b32 v195, 0xffff0000, v224
    v_lshlrev_b32 v191, 16, v225
    s_waitcnt lgkmcnt(0)
    v_mfma_f32_16x16x32_f16 v[168:171], v[128:131], v[232:235], v[168:171]
    v_and_b32 v194, 0xffff0000, v225
    v_lshlrev_b32 v190, 16, v226
    v_mfma_f32_16x16x32_f16 v[172:175], v[120:123], v[232:235], v[172:175]
    v_and_b32 v193, 0xffff0000, v226
    v_lshlrev_b32 v189, 16, v227
    v_mfma_f32_16x16x32_f16 v[176:179], v[128:131], v[232:235], v[176:179]
    v_and_b32 v192, 0xffff0000, v227
    v_lshlrev_b32 v188, 16, v249
    ds_read_b128 v[212:215], v240 offset:0
    ds_read_b128 v[216:219], v241 offset:32768
    ds_read_b32 v248, v254 offset:32768
    ds_read_b128 v[220:223], v240 offset:2048
    ds_read_b128 v[224:227], v242 offset:32768
    ds_read_b32 v249, v255 offset:32768
    v_mfma_f32_16x16x32_f16 v[180:183], v[116:119], v[108:111], v[180:183]
    v_mfma_f32_16x16x32_f16 v[184:187], v[124:127], v[108:111], v[184:187]
    v_mfma_f32_16x16x32_f16 v[188:191], v[116:119], v[108:111], v[188:191]
    v_mfma_f32_16x16x32_f16 v[192:195], v[124:127], v[108:111], v[192:195]
    v_cvt_pk_bf16_f32 v132, v164, v168
    v_cvt_pk_bf16_f32 v133, v165, v169
    v_mfma_f32_16x16x32_f16 v[180:183], v[120:123], v[112:115], v[180:183]
    v_cvt_pk_bf16_f32 v134, v166, v170
    v_cvt_pk_bf16_f32 v135, v167, v171
    v_mfma_f32_16x16x32_f16 v[184:187], v[128:131], v[112:115], v[184:187]
    v_cvt_pk_bf16_f32 v136, v179, v175
    v_mfma_f32_16x16x32_f16 v[188:191], v[120:123], v[112:115], v[188:191]
    v_cvt_pk_bf16_f32 v137, v178, v174
    v_cvt_pk_bf16_f32 v138, v177, v173
    v_mfma_f32_16x16x32_f16 v[192:195], v[128:131], v[112:115], v[192:195]
    v_cvt_pk_bf16_f32 v139, v176, v172
    s_nop 1
    v_cvt_pk_bf16_f32 v140, v180, v184
    v_cvt_pk_bf16_f32 v141, v181, v185
    v_cvt_pk_bf16_f32 v142, v182, v186
    v_cvt_pk_bf16_f32 v143, v183, v187
    s_nop 0
    v_cvt_pk_bf16_f32 v144, v195, v191
    v_cvt_pk_bf16_f32 v145, v194, v190
    v_cvt_pk_bf16_f32 v146, v193, v189
    v_cvt_pk_bf16_f32 v147, v192, v188
    s_waitcnt vmcnt(4)
    ds_read_b64_tr_b16 v[148:149], v236 offset:0
    ds_read_b64_tr_b16 v[150:151], v236 offset:512
    ds_read_b64_tr_b16 v[152:153], v236 offset:20480
    ds_read_b64_tr_b16 v[154:155], v236 offset:20992
    ds_read_b64_tr_b16 v[156:157], v237 offset:0
    ds_read_b64_tr_b16 v[158:159], v237 offset:512
    ds_read_b64_tr_b16 v[160:161], v237 offset:20480
    ds_read_b64_tr_b16 v[162:163], v237 offset:20992
    s_waitcnt vmcnt(0)
    ds_read_b64_tr_b16 v[116:117], v236 offset:8192
    ds_read_b64_tr_b16 v[118:119], v236 offset:8704
    ds_read_b64_tr_b16 v[120:121], v236 offset:28672
    ds_read_b64_tr_b16 v[122:123], v236 offset:29184
    ds_read_b64_tr_b16 v[124:125], v237 offset:8192
    ds_read_b64_tr_b16 v[126:127], v237 offset:8704
    ds_read_b64_tr_b16 v[128:129], v237 offset:28672
    ds_read_b64_tr_b16 v[130:131], v237 offset:29184
    s_waitcnt lgkmcnt(0)
    s_barrier
    ds_write_b128 v245, v[132:135] offset:16384
    ds_write_b128 v246, v[136:139] offset:16384
    ds_write_b128 v245, v[140:143] offset:36864
    ds_write_b128 v247, v[144:147] offset:16384
    v_lshlrev_b32 v164, 16, v212
    v_and_b32 v168, 0xffff0000, v212
    v_lshlrev_b32 v165, 16, v213
    v_and_b32 v169, 0xffff0000, v213
    v_lshlrev_b32 v166, 16, v214
    v_and_b32 v170, 0xffff0000, v214
    v_lshlrev_b32 v167, 16, v215
    v_and_b32 v171, 0xffff0000, v215
    v_and_b32 v179, 0xffff0000, v216
    v_lshlrev_b32 v175, 16, v217
    v_and_b32 v178, 0xffff0000, v217
    v_lshlrev_b32 v174, 16, v218
    v_and_b32 v177, 0xffff0000, v218
    v_lshlrev_b32 v173, 16, v219
    v_and_b32 v176, 0xffff0000, v219
    v_lshlrev_b32 v172, 16, v248
    v_mov_b32 v238, v164
    v_mfma_f32_16x16x32_f16 v[164:167], v[148:151], v[228:231], v[164:167]
    v_lshlrev_b32 v180, 16, v220
    v_and_b32 v184, 0xffff0000, v220
    v_lshlrev_b32 v181, 16, v221
    v_mfma_f32_16x16x32_f16 v[168:171], v[156:159], v[228:231], v[168:171]
    v_and_b32 v185, 0xffff0000, v221
    v_lshlrev_b32 v182, 16, v222
    v_mfma_f32_16x16x32_f16 v[172:175], v[148:151], v[228:231], v[172:175]
    v_and_b32 v186, 0xffff0000, v222
    v_lshlrev_b32 v183, 16, v223
    v_mfma_f32_16x16x32_f16 v[176:179], v[156:159], v[228:231], v[176:179]
    v_and_b32 v187, 0xffff0000, v223
    v_and_b32 v195, 0xffff0000, v224
    v_mfma_f32_16x16x32_f16 v[164:167], v[152:155], v[232:235], v[164:167]
    v_lshlrev_b32 v191, 16, v225
    v_and_b32 v194, 0xffff0000, v225
    v_mfma_f32_16x16x32_f16 v[168:171], v[160:163], v[232:235], v[168:171]
    v_lshlrev_b32 v190, 16, v226
    v_and_b32 v193, 0xffff0000, v226
    v_mfma_f32_16x16x32_f16 v[172:175], v[152:155], v[232:235], v[172:175]
    v_lshlrev_b32 v189, 16, v227
    v_and_b32 v192, 0xffff0000, v227
    v_mfma_f32_16x16x32_f16 v[176:179], v[160:163], v[232:235], v[176:179]
    v_lshlrev_b32 v188, 16, v249
    v_mov_b32 v239, v180
    ds_read_b128 v[212:215], v240 offset:16384
    ds_read_b128 v[216:219], v241 offset:16384
    ds_read_b32 v248, v243 offset:16384
    ds_read_b128 v[220:223], v240 offset:18432
    ds_read_b128 v[224:227], v242 offset:16384
    ds_read_b32 v249, v244 offset:16384
    v_mfma_f32_16x16x32_f16 v[180:183], v[148:151], v[108:111], v[180:183]
    v_mfma_f32_16x16x32_f16 v[184:187], v[156:159], v[108:111], v[184:187]
    v_mfma_f32_16x16x32_f16 v[188:191], v[148:151], v[108:111], v[188:191]
    v_mfma_f32_16x16x32_f16 v[192:195], v[156:159], v[108:111], v[192:195]
    v_cndmask_b32 v164, v164, v238, s[42:43]
    v_cvt_pk_bf16_f32 v196, v164, v168
    v_cvt_pk_bf16_f32 v197, v165, v169
    v_mfma_f32_16x16x32_f16 v[180:183], v[152:155], v[112:115], v[180:183]
    v_cvt_pk_bf16_f32 v198, v166, v170
    v_cvt_pk_bf16_f32 v199, v167, v171
    v_mfma_f32_16x16x32_f16 v[184:187], v[160:163], v[112:115], v[184:187]
    ds_write_b128 v245, v[196:199] offset:0
    v_cvt_pk_bf16_f32 v200, v179, v175
    v_mfma_f32_16x16x32_f16 v[188:191], v[152:155], v[112:115], v[188:191]
    v_cvt_pk_bf16_f32 v201, v178, v174
    v_cvt_pk_bf16_f32 v202, v177, v173
    v_mfma_f32_16x16x32_f16 v[192:195], v[160:163], v[112:115], v[192:195]
    v_cvt_pk_bf16_f32 v203, v176, v172
    ds_write_b128 v246, v[200:203] offset:0
    v_cndmask_b32 v180, v180, v239, s[42:43]
    v_cvt_pk_bf16_f32 v204, v180, v184
    v_cvt_pk_bf16_f32 v205, v181, v185
    v_cvt_pk_bf16_f32 v206, v182, v186
    v_cvt_pk_bf16_f32 v207, v183, v187
    ds_write_b128 v245, v[204:207] offset:20480
    v_cvt_pk_bf16_f32 v208, v195, v191
    v_cvt_pk_bf16_f32 v209, v194, v190
    v_cvt_pk_bf16_f32 v210, v193, v189
    v_cvt_pk_bf16_f32 v211, v192, v188
    ds_write_b128 v247, v[208:211] offset:0
    buffer_load_dwordx4 v[76:79], v1, s[8:11], s47 offen offset:1024
    buffer_load_dwordx4 v[80:83], v2, s[8:11], s47 offen offset:1024
    buffer_load_dwordx4 v[84:87], v1, s[8:11], s47 offen offset:2048
    buffer_load_dwordx4 v[88:91], v2, s[8:11], s47 offen offset:2048
    buffer_load_dwordx4 v[92:95], v1, s[8:11], s47 offen offset:3072
    buffer_load_dwordx4 v[96:99], v2, s[8:11], s47 offen offset:3072
    s_waitcnt lgkmcnt(9)
    v_lshlrev_b32 v164, 16, v212
    v_and_b32 v168, 0xffff0000, v212
    v_lshlrev_b32 v165, 16, v213
    v_and_b32 v169, 0xffff0000, v213
    v_lshlrev_b32 v166, 16, v214
    v_and_b32 v170, 0xffff0000, v214
    v_lshlrev_b32 v167, 16, v215
    v_and_b32 v171, 0xffff0000, v215
    s_waitcnt lgkmcnt(8)
    v_and_b32 v179, 0xffff0000, v216
    v_lshlrev_b32 v175, 16, v217
    v_and_b32 v178, 0xffff0000, v217
    v_lshlrev_b32 v174, 16, v218
    v_and_b32 v177, 0xffff0000, v218
    v_lshlrev_b32 v173, 16, v219
    v_and_b32 v176, 0xffff0000, v219
    s_waitcnt lgkmcnt(7)
    v_lshlrev_b32 v172, 16, v248
    v_mfma_f32_16x16x32_f16 v[164:167], v[116:119], v[228:231], v[164:167]
    s_waitcnt lgkmcnt(6)
    v_lshlrev_b32 v180, 16, v220
    v_and_b32 v184, 0xffff0000, v220
    v_mfma_f32_16x16x32_f16 v[168:171], v[124:127], v[228:231], v[168:171]
    v_lshlrev_b32 v181, 16, v221
    v_and_b32 v185, 0xffff0000, v221
    v_mfma_f32_16x16x32_f16 v[172:175], v[116:119], v[228:231], v[172:175]
    v_lshlrev_b32 v182, 16, v222
    v_and_b32 v186, 0xffff0000, v222
    v_mfma_f32_16x16x32_f16 v[176:179], v[124:127], v[228:231], v[176:179]
    v_lshlrev_b32 v183, 16, v223
    v_and_b32 v187, 0xffff0000, v223
    v_mfma_f32_16x16x32_f16 v[164:167], v[120:123], v[232:235], v[164:167]
    s_waitcnt lgkmcnt(5)
    v_and_b32 v195, 0xffff0000, v224
    v_lshlrev_b32 v191, 16, v225
    v_mfma_f32_16x16x32_f16 v[168:171], v[128:131], v[232:235], v[168:171]
    v_and_b32 v194, 0xffff0000, v225
    v_lshlrev_b32 v190, 16, v226
    v_mfma_f32_16x16x32_f16 v[172:175], v[120:123], v[232:235], v[172:175]
    v_and_b32 v193, 0xffff0000, v226
    v_lshlrev_b32 v189, 16, v227
    v_mfma_f32_16x16x32_f16 v[176:179], v[128:131], v[232:235], v[176:179]
    v_and_b32 v192, 0xffff0000, v227
    s_waitcnt lgkmcnt(4)
    v_lshlrev_b32 v188, 16, v249
    v_mfma_f32_16x16x32_f16 v[180:183], v[116:119], v[108:111], v[180:183]
    v_mfma_f32_16x16x32_f16 v[184:187], v[124:127], v[108:111], v[184:187]
    v_mfma_f32_16x16x32_f16 v[188:191], v[116:119], v[108:111], v[188:191]
    v_mfma_f32_16x16x32_f16 v[192:195], v[124:127], v[108:111], v[192:195]
    v_cvt_pk_bf16_f32 v196, v164, v168
    v_cvt_pk_bf16_f32 v197, v165, v169
    v_mfma_f32_16x16x32_f16 v[180:183], v[120:123], v[112:115], v[180:183]
    v_cvt_pk_bf16_f32 v198, v166, v170
    v_cvt_pk_bf16_f32 v199, v167, v171
    v_mfma_f32_16x16x32_f16 v[184:187], v[128:131], v[112:115], v[184:187]
    ds_write_b128 v245, v[196:199] offset:8192
    v_cvt_pk_bf16_f32 v200, v179, v175
    v_mfma_f32_16x16x32_f16 v[188:191], v[120:123], v[112:115], v[188:191]
    v_cvt_pk_bf16_f32 v201, v178, v174
    v_cvt_pk_bf16_f32 v202, v177, v173
    v_mfma_f32_16x16x32_f16 v[192:195], v[128:131], v[112:115], v[192:195]
    v_cvt_pk_bf16_f32 v203, v176, v172
    ds_write_b128 v246, v[200:203] offset:8192
    v_cvt_pk_bf16_f32 v204, v180, v184
    v_cvt_pk_bf16_f32 v205, v181, v185
    v_cvt_pk_bf16_f32 v206, v182, v186
    v_cvt_pk_bf16_f32 v207, v183, v187
    ds_write_b128 v245, v[204:207] offset:28672
    s_nop 0
    v_cvt_pk_bf16_f32 v208, v195, v191
    v_cvt_pk_bf16_f32 v209, v194, v190
    v_cvt_pk_bf16_f32 v210, v193, v189
    v_cvt_pk_bf16_f32 v211, v192, v188
    ds_write_b128 v247, v[208:211] offset:8192
    s_branch HO_END
HO_LO:
    s_cmp_eq_u32 s16, 0
    s_cselect_b64 s[24:25], -1, 0
    s_cmp_eq_u32 s16, 7
    s_cselect_b64 s[26:27], -1, 0
    s_min_u32 s40, s20, 5
    v_min_u32 v164, 6, v250
    s_and_b32 s41, s19, 3
    s_mul_i32 s41, s41, 0
    s_cmp_ge_u32 s41, 14
    s_cselect_b32 s21, 14, 0
    s_sub_u32 s41, s41, s21
    s_cmp_ge_u32 s41, 7
    s_cselect_b32 s21, 7, 0
    s_sub_u32 s41, s41, s21
    v_add3_u32 v165, v164, s41, -1
    v_subrev_u32 v167, 7, v165
    v_min_u32 v165, v165, v167
    v_add3_u32 v165, v165, s20, 1
    v_and_b32 v165, 7, v165
    v_add_u32 v166, s40, v164
    v_subrev_u32 v167, 6, v166
    v_min_u32 v166, v166, v167
    v_cndmask_b32 v165, v165, v166, s[26:27]
    s_cmp_eq_u32 s41, 0
    s_cselect_b32 s41, 7, s41
    s_add_u32 s40, s20, s41
    s_and_b32 s40, s40, 7
    v_mov_b32 v166, s40
    v_cndmask_b32 v165, v165, v166, s[24:25]
    v_mov_b32 v166, s16
    v_cndmask_b32 v164, v166, v164, s[24:25]
    v_mul_u32_u24 v166, 7, v165
    v_min_u32 v166, 48, v166
    v_add3_u32 v166, v166, v164, -1
    s_nop 0
    v_readlane_b32 s93, v166, 1
    v_readlane_b32 s94, v166, 2
    v_readlane_b32 s95, v166, 3
    v_readlane_b32 s96, v166, 4
    v_readlane_b32 s97, v166, 5
    v_readlane_b32 s98, v166, 6
    s_mov_b32 s92, s44
    s_cmp_lt_u32 s20, 6
    s_cselect_b32 s41, s16, 0
    s_cmp_eq_u32 s41, 7
    s_cselect_b32 s98, 0xc000, s98
    s_mul_i32 s100, s20, 276480
    s_add_u32 s100, s100, 3522560
    s_mul_i32 s101, s19, 221184
    s_add_u32 s101, s101, 5843968
    s_lshl_b32 s99, s19, 10
    s_add_u32 s99, s99, 5770240
    s_lshl_b32 s40, s40, 7
    s_add_u32 s40, s40, 32
    s_lshl_b32 s90, s16, 7
    s_cmp_eq_u32 s16, 0
    s_cselect_b32 s90, s40, s90
    s_add_u32 s90, s90, s99
    s_lshl_b32 s91, s16, 7
    s_lshl_b32 s40, s20, 2
    s_add_u32 s91, s91, s40
    s_lshl_b32 s17, s20, 7
    s_lshl_b32 s40, s16, 2
    s_add_u32 s17, s17, s40
    s_add_u32 s17, s17, 32
    v_mov_b32 v164, 73728
HO_S1:
    ds_read_b32 v165, v164 offset:8
    s_waitcnt lgkmcnt(0)
    v_cmp_ne_u32 vcc, 1, v165
    s_cbranch_vccnz HO_S1
    s_lshl_b32 s40, s44, 9
    s_add_u32 s40, s40, 5742592
    v_and_b32 v160, 0x1ff, v1
    buffer_load_dwordx4 v[148:151], v160, s[8:11], s40 offen
    s_lshl_b32 s40, s44, 6
    v_lshlrev_b32 v160, 3, v252
    buffer_load_dwordx2 v[104:105], v160, s[4:7], s40 offen
    buffer_load_dwordx2 v[106:107], v160, s[4:7], s40 offen offset:32
    s_add_u32 s47, s46, 0
    buffer_load_dwordx4 v[4:7], v1, s[8:11], s47 offen offset:0
    buffer_load_dwordx4 v[8:11], v2, s[8:11], s47 offen offset:0
    s_setprio 0
    s_cmp_lt_u32 s16, 2
    s_cselect_b32 s27, 50, 49
    s_cmp_eq_u32 s16, 3
    s_cselect_b32 s27, 51, s27
    s_waitcnt lgkmcnt(0)
    s_and_b32 s40, s19, 31
    s_mul_i32 s40, s40, 4
    s_and_b32 s41, s16, 3
    s_add_u32 s40, s40, s41
    s_lshl_b32 s40, s40, 7
    s_add_u32 s40, s40, 5823488
    s_mov_b32 s41, 0x8000
HO_G1:
    s_load_dword s26, s[8:9], s40 glc
    s_waitcnt lgkmcnt(0)
    s_sub_u32 s41, s41, 1
    s_cbranch_scc1 HO_G1D
    s_cmp_lg_u32 s26, s27
    s_cbranch_scc1 HO_G1
HO_G1D:
    s_waitcnt lgkmcnt(0)
    s_barrier
    s_add_u32 m0, s58, 0
    s_add_u32 s27, s22, 0
    buffer_load_dwordx4 v1, s[8:11], s27 offen lds
    s_add_u32 m0, s58, 20480
    s_add_u32 s27, s22, 1024
    buffer_load_dwordx4 v1, s[8:11], s27 offen lds
    s_add_u32 m0, s59, 0
    s_add_u32 s27, s22, 2048
    buffer_load_dwordx4 v1, s[8:11], s27 offen lds
    s_add_u32 m0, s59, 20480
    s_add_u32 s27, s22, 3072
    buffer_load_dwordx4 v1, s[8:11], s27 offen lds
    s_add_u32 m0, s58, 8192
    s_add_u32 s27, s22, 16384
    buffer_load_dwordx4 v1, s[8:11], s27 offen lds
    s_add_u32 m0, s58, 28672
    s_add_u32 s27, s22, 17408
    buffer_load_dwordx4 v1, s[8:11], s27 offen lds
    s_add_u32 m0, s59, 8192
    s_add_u32 s27, s22, 18432
    buffer_load_dwordx4 v1, s[8:11], s27 offen lds
    s_add_u32 m0, s59, 28672
    s_add_u32 s27, s22, 19456
    buffer_load_dwordx4 v1, s[8:11], s27 offen lds
    buffer_load_dwordx4 v[12:15], v1, s[8:11], s47 offen offset:1024
    buffer_load_dwordx4 v[16:19], v2, s[8:11], s47 offen offset:1024
    buffer_load_dwordx4 v[20:23], v1, s[8:11], s47 offen offset:2048
    buffer_load_dwordx4 v[24:27], v2, s[8:11], s47 offen offset:2048
    ds_read_b128 v[212:215], v240 offset:0
    ds_read_b128 v[216:219], v241 offset:32768
    ds_read_b32 v248, v254 offset:32768
    ds_read_b128 v[220:223], v240 offset:2048
    ds_read_b128 v[224:227], v242 offset:32768
    ds_read_b32 v249, v255 offset:32768
    s_waitcnt vmcnt(16)
    v_add_f32_dpp v148, v148, v148 row_ror:8 row_mask:0xf bank_mask:0xf
    v_add_f32_dpp v149, v149, v149 row_ror:8 row_mask:0xf bank_mask:0xf
    v_add_f32_dpp v150, v150, v150 row_ror:8 row_mask:0xf bank_mask:0xf
    v_add_f32_dpp v151, v151, v151 row_ror:8 row_mask:0xf bank_mask:0xf
    v_mov_b32 v152, v148
    v_mov_b32 v153, v149
    v_mov_b32 v154, v150
    v_mov_b32 v155, v151
    v_permlane16_swap_b32 v148, v152
    v_permlane16_swap_b32 v149, v153
    v_permlane16_swap_b32 v150, v154
    v_permlane16_swap_b32 v151, v155
    v_add_f32 v100, v148, v152
    v_add_f32 v101, v149, v153
    v_add_f32 v102, v150, v154
    v_add_f32 v103, v151, v155
    s_waitcnt vmcnt(8)
    ds_read_b64_tr_b16 v[116:117], v236 offset:0
    ds_read_b64_tr_b16 v[118:119], v236 offset:512
    ds_read_b64_tr_b16 v[120:121], v236 offset:20480
    ds_read_b64_tr_b16 v[122:123], v236 offset:20992
    ds_read_b64_tr_b16 v[124:125], v237 offset:0
    ds_read_b64_tr_b16 v[126:127], v237 offset:512
    ds_read_b64_tr_b16 v[128:129], v237 offset:20480
    ds_read_b64_tr_b16 v[130:131], v237 offset:20992
    s_waitcnt lgkmcnt(13)
    v_lshlrev_b32 v164, 16, v212
    v_and_b32 v168, 0xffff0000, v212
    v_lshlrev_b32 v165, 16, v213
    v_and_b32 v169, 0xffff0000, v213
    v_lshlrev_b32 v166, 16, v214
    v_and_b32 v170, 0xffff0000, v214
    v_lshlrev_b32 v167, 16, v215
    v_and_b32 v171, 0xffff0000, v215
    s_waitcnt lgkmcnt(12)
    v_and_b32 v179, 0xffff0000, v216
    v_lshlrev_b32 v175, 16, v217
    v_and_b32 v178, 0xffff0000, v217
    v_lshlrev_b32 v174, 16, v218
    v_and_b32 v177, 0xffff0000, v218
    v_lshlrev_b32 v173, 16, v219
    v_and_b32 v176, 0xffff0000, v219
    s_waitcnt lgkmcnt(11)
    v_lshlrev_b32 v172, 16, v248
    v_mov_b32 v238, v164
    s_waitcnt lgkmcnt(6)
    v_mfma_f32_16x16x32_f16 v[164:167], v[116:119], v[228:231], v[164:167]
    v_lshlrev_b32 v180, 16, v220
    v_and_b32 v184, 0xffff0000, v220
    v_lshlrev_b32 v181, 16, v221
    s_waitcnt lgkmcnt(2)
    v_mfma_f32_16x16x32_f16 v[168:171], v[124:127], v[228:231], v[168:171]
    v_and_b32 v185, 0xffff0000, v221
    v_lshlrev_b32 v182, 16, v222
    v_mfma_f32_16x16x32_f16 v[172:175], v[116:119], v[228:231], v[172:175]
    v_and_b32 v186, 0xffff0000, v222
    v_lshlrev_b32 v183, 16, v223
    v_mfma_f32_16x16x32_f16 v[176:179], v[124:127], v[228:231], v[176:179]
    v_and_b32 v187, 0xffff0000, v223
    v_and_b32 v195, 0xffff0000, v224
    v_mfma_f32_16x16x32_f16 v[164:167], v[120:123], v[232:235], v[164:167]
    v_lshlrev_b32 v191, 16, v225
    v_and_b32 v194, 0xffff0000, v225
    s_waitcnt lgkmcnt(0)
    v_mfma_f32_16x16x32_f16 v[168:171], v[128:131], v[232:235], v[168:171]
    v_lshlrev_b32 v190, 16, v226
    v_and_b32 v193, 0xffff0000, v226
    v_mfma_f32_16x16x32_f16 v[172:175], v[120:123], v[232:235], v[172:175]
    v_lshlrev_b32 v189, 16, v227
    v_and_b32 v192, 0xffff0000, v227
    v_mfma_f32_16x16x32_f16 v[176:179], v[128:131], v[232:235], v[176:179]
    v_lshlrev_b32 v188, 16, v249
    v_mov_b32 v239, v180
    ds_read_b128 v[212:215], v240 offset:16384
    ds_read_b128 v[216:219], v241 offset:16384
    ds_read_b32 v248, v243 offset:16384
    ds_read_b128 v[220:223], v240 offset:18432
    ds_read_b128 v[224:227], v242 offset:16384
    ds_read_b32 v249, v244 offset:16384
    v_mfma_f32_16x16x32_f16 v[180:183], v[116:119], v[108:111], v[180:183]
    v_mfma_f32_16x16x32_f16 v[184:187], v[124:127], v[108:111], v[184:187]
    v_mfma_f32_16x16x32_f16 v[188:191], v[116:119], v[108:111], v[188:191]
    v_mfma_f32_16x16x32_f16 v[192:195], v[124:127], v[108:111], v[192:195]
    v_cndmask_b32 v164, v164, v238, s[42:43]
    v_cvt_pk_bf16_f32 v132, v164, v168
    v_mfma_f32_16x16x32_f16 v[180:183], v[120:123], v[112:115], v[180:183]
    v_cvt_pk_bf16_f32 v133, v165, v169
    v_cvt_pk_bf16_f32 v134, v166, v170
    v_mfma_f32_16x16x32_f16 v[184:187], v[128:131], v[112:115], v[184:187]
    v_cvt_pk_bf16_f32 v135, v167, v171
    v_cvt_pk_bf16_f32 v136, v179, v175
    v_mfma_f32_16x16x32_f16 v[188:191], v[120:123], v[112:115], v[188:191]
    v_cvt_pk_bf16_f32 v137, v178, v174
    v_cvt_pk_bf16_f32 v138, v177, v173
    v_mfma_f32_16x16x32_f16 v[192:195], v[128:131], v[112:115], v[192:195]
    v_cvt_pk_bf16_f32 v139, v176, v172
    v_cndmask_b32 v180, v180, v239, s[42:43]
    v_cvt_pk_bf16_f32 v140, v180, v184
    v_cvt_pk_bf16_f32 v141, v181, v185
    v_cvt_pk_bf16_f32 v142, v182, v186
    v_cvt_pk_bf16_f32 v143, v183, v187
    s_nop 1
    v_cvt_pk_bf16_f32 v144, v195, v191
    v_cvt_pk_bf16_f32 v145, v194, v190
    v_cvt_pk_bf16_f32 v146, v193, v189
    v_cvt_pk_bf16_f32 v147, v192, v188
    s_waitcnt vmcnt(4)
    ds_read_b64_tr_b16 v[148:149], v236 offset:8192
    ds_read_b64_tr_b16 v[150:151], v236 offset:8704
    ds_read_b64_tr_b16 v[152:153], v236 offset:28672
    ds_read_b64_tr_b16 v[154:155], v236 offset:29184
    ds_read_b64_tr_b16 v[156:157], v237 offset:8192
    ds_read_b64_tr_b16 v[158:159], v237 offset:8704
    ds_read_b64_tr_b16 v[160:161], v237 offset:28672
    ds_read_b64_tr_b16 v[162:163], v237 offset:29184
    buffer_load_dwordx4 v[28:31], v1, s[8:11], s47 offen offset:3072
    buffer_load_dwordx4 v[32:35], v2, s[8:11], s47 offen offset:3072
    s_add_u32 s47, s46, 4096
    buffer_load_dwordx4 v[36:39], v1, s[8:11], s47 offen offset:0
    buffer_load_dwordx4 v[40:43], v2, s[8:11], s47 offen offset:0
    buffer_load_dwordx4 v[44:47], v1, s[8:11], s47 offen offset:1024
    buffer_load_dwordx4 v[48:51], v2, s[8:11], s47 offen offset:1024
    s_waitcnt lgkmcnt(0)
    s_barrier
    s_cmp_lg_u32 s16, 0
    s_cbranch_scc1 HO_N2
    s_mov_b32 s40, s18
    s_and_b32 s40, s40, 3
    s_lshl_b32 s40, s40, 7
    s_add_u32 s40, s40, 5803008
    v_mul_u32_u24 v164, 512, v250
    v_mov_b32 v165, 1
    s_mov_b32 exec_hi, 0
    s_mov_b32 exec_lo, 0xffffffff
    buffer_atomic_add v165, v164, s[8:11], s40 offen offset:0 sc1
    s_mov_b64 exec, -1
HO_N2:
    ds_write_b128 v245, v[132:135] offset:0
    ds_write_b128 v246, v[136:139] offset:0
    ds_write_b128 v245, v[140:143] offset:20480
    ds_write_b128 v247, v[144:147] offset:0
    v_lshlrev_b32 v164, 16, v212
    v_and_b32 v168, 0xffff0000, v212
    v_lshlrev_b32 v165, 16, v213
    v_and_b32 v169, 0xffff0000, v213
    v_lshlrev_b32 v166, 16, v214
    v_and_b32 v170, 0xffff0000, v214
    v_lshlrev_b32 v167, 16, v215
    v_and_b32 v171, 0xffff0000, v215
    v_and_b32 v179, 0xffff0000, v216
    v_lshlrev_b32 v175, 16, v217
    v_and_b32 v178, 0xffff0000, v217
    v_lshlrev_b32 v174, 16, v218
    v_and_b32 v177, 0xffff0000, v218
    v_lshlrev_b32 v173, 16, v219
    v_and_b32 v176, 0xffff0000, v219
    v_lshlrev_b32 v172, 16, v248
    v_mfma_f32_16x16x32_f16 v[164:167], v[148:151], v[228:231], v[164:167]
    v_lshlrev_b32 v180, 16, v220
    v_and_b32 v184, 0xffff0000, v220
    v_mfma_f32_16x16x32_f16 v[168:171], v[156:159], v[228:231], v[168:171]
    v_lshlrev_b32 v181, 16, v221
    v_and_b32 v185, 0xffff0000, v221
    v_mfma_f32_16x16x32_f16 v[172:175], v[148:151], v[228:231], v[172:175]
    v_lshlrev_b32 v182, 16, v222
    v_and_b32 v186, 0xffff0000, v222
    v_mfma_f32_16x16x32_f16 v[176:179], v[156:159], v[228:231], v[176:179]
    v_lshlrev_b32 v183, 16, v223
    v_and_b32 v187, 0xffff0000, v223
    v_mfma_f32_16x16x32_f16 v[164:167], v[152:155], v[232:235], v[164:167]
    v_and_b32 v195, 0xffff0000, v224
    v_lshlrev_b32 v191, 16, v225
    v_mfma_f32_16x16x32_f16 v[168:171], v[160:163], v[232:235], v[168:171]
    v_and_b32 v194, 0xffff0000, v225
    v_lshlrev_b32 v190, 16, v226
    v_mfma_f32_16x16x32_f16 v[172:175], v[152:155], v[232:235], v[172:175]
    v_and_b32 v193, 0xffff0000, v226
    v_lshlrev_b32 v189, 16, v227
    v_mfma_f32_16x16x32_f16 v[176:179], v[160:163], v[232:235], v[176:179]
    v_and_b32 v192, 0xffff0000, v227
    v_lshlrev_b32 v188, 16, v249
    v_mfma_f32_16x16x32_f16 v[180:183], v[148:151], v[108:111], v[180:183]
    v_mfma_f32_16x16x32_f16 v[184:187], v[156:159], v[108:111], v[184:187]
    v_mfma_f32_16x16x32_f16 v[188:191], v[148:151], v[108:111], v[188:191]
    v_mfma_f32_16x16x32_f16 v[192:195], v[156:159], v[108:111], v[192:195]
    v_cvt_pk_bf16_f32 v196, v164, v168
    v_cvt_pk_bf16_f32 v197, v165, v169
    v_mfma_f32_16x16x32_f16 v[180:183], v[152:155], v[112:115], v[180:183]
    v_cvt_pk_bf16_f32 v198, v166, v170
    v_cvt_pk_bf16_f32 v199, v167, v171
    v_mfma_f32_16x16x32_f16 v[184:187], v[160:163], v[112:115], v[184:187]
    ds_write_b128 v245, v[196:199] offset:8192
    v_cvt_pk_bf16_f32 v200, v179, v175
    v_mfma_f32_16x16x32_f16 v[188:191], v[152:155], v[112:115], v[188:191]
    v_cvt_pk_bf16_f32 v201, v178, v174
    v_cvt_pk_bf16_f32 v202, v177, v173
    v_mfma_f32_16x16x32_f16 v[192:195], v[160:163], v[112:115], v[192:195]
    v_cvt_pk_bf16_f32 v203, v176, v172
    ds_write_b128 v246, v[200:203] offset:8192
    v_cvt_pk_bf16_f32 v204, v180, v184
    v_cvt_pk_bf16_f32 v205, v181, v185
    v_cvt_pk_bf16_f32 v206, v182, v186
    v_cvt_pk_bf16_f32 v207, v183, v187
    ds_write_b128 v245, v[204:207] offset:28672
    s_nop 0
    v_cvt_pk_bf16_f32 v208, v195, v191
    v_cvt_pk_bf16_f32 v209, v194, v190
    v_cvt_pk_bf16_f32 v210, v193, v189
    v_cvt_pk_bf16_f32 v211, v192, v188
    ds_write_b128 v247, v[208:211] offset:8192
    buffer_load_dwordx4 v[52:55], v1, s[8:11], s47 offen offset:2048
    buffer_load_dwordx4 v[56:59], v2, s[8:11], s47 offen offset:2048
    buffer_load_dwordx4 v[60:63], v1, s[8:11], s47 offen offset:3072
    buffer_load_dwordx4 v[64:67], v2, s[8:11], s47 offen offset:3072
    s_add_u32 s47, s46, 8192
    buffer_load_dwordx4 v[68:71], v1, s[8:11], s47 offen offset:0
    buffer_load_dwordx4 v[72:75], v2, s[8:11], s47 offen offset:0
    buffer_load_dwordx4 v[76:79], v1, s[8:11], s47 offen offset:1024
    buffer_load_dwordx4 v[80:83], v2, s[8:11], s47 offen offset:1024
    buffer_load_dwordx4 v[84:87], v1, s[8:11], s47 offen offset:2048
    buffer_load_dwordx4 v[88:91], v2, s[8:11], s47 offen offset:2048
    buffer_load_dwordx4 v[92:95], v1, s[8:11], s47 offen offset:3072
    buffer_load_dwordx4 v[96:99], v2, s[8:11], s47 offen offset:3072
HO_END:
    s_waitcnt lgkmcnt(0)
    s_barrier
    s_cmp_eq_u32 s16, 0
    s_cbranch_scc1 K2_W0
    s_setprio 3
    ds_read_b128 v[180:183], v3 offset:0
    ds_read_b128 v[184:187], v3 offset:20480
    ds_read_b128 v[188:191], v3 offset:1024
    ds_read_b128 v[192:195], v3 offset:21504
    ds_read_b128 v[196:199], v3 offset:2048
    ds_read_b128 v[200:203], v3 offset:22528
    ds_read_b128 v[204:207], v3 offset:3072
    s_lshl_b32 s41, s16, 7
    s_add_u32 s41, s41, 160768
    v_and_b32 v236, 0x70, v1
    v_add_u32 v236, s41, v236
    ds_write_b128 v236, v[100:103]
    v_lshl_add_u32 v237, v252, 4, s41
    v_lshlrev_b32 v224, 16, v104
    v_and_b32 v225, 0xffff0000, v104
    v_lshlrev_b32 v226, 16, v105
    v_and_b32 v227, 0xffff0000, v105
    v_lshlrev_b32 v228, 16, v106
    v_and_b32 v229, 0xffff0000, v106
    v_lshlrev_b32 v230, 16, v107
    v_and_b32 v231, 0xffff0000, v107
    ds_read_b128 v[220:223], v237
    ds_read_b128 v[232:235], v237 offset:64
    s_waitcnt vmcnt(23) lgkmcnt(9)
    v_mfma_f32_16x16x32_bf16 v[164:167], v[4:7], v[180:183], 0
    s_waitcnt vmcnt(22)
    v_mfma_f32_16x16x32_bf16 v[172:175], v[8:11], v[180:183], 0
    ds_read_b128 v[208:211], v3 offset:23552
    s_add_u32 s47, s46, 12288
    buffer_load_dwordx4 v[100:103], v1, s[8:11], s47 offen offset:0
    s_waitcnt lgkmcnt(9)
    v_mfma_f32_16x16x32_bf16 v[168:171], v[4:7], v[184:187], 0
    v_mfma_f32_16x16x32_bf16 v[176:179], v[8:11], v[184:187], 0
    ds_read_b128 v[180:183], v3 offset:4096
    buffer_load_dwordx4 v[104:107], v2, s[8:11], s47 offen offset:0
    s_barrier
    s_waitcnt vmcnt(23) lgkmcnt(9)
    v_mfma_f32_16x16x32_bf16 v[164:167], v[12:15], v[188:191], v[164:167]
    s_waitcnt vmcnt(22)
    v_mfma_f32_16x16x32_bf16 v[172:175], v[16:19], v[188:191], v[172:175]
    ds_read_b128 v[184:187], v3 offset:24576
    buffer_load_dwordx4 v[108:111], v1, s[8:11], s47 offen offset:1024
    s_waitcnt lgkmcnt(9)
    v_mfma_f32_16x16x32_bf16 v[168:171], v[12:15], v[192:195], v[168:171]
    v_mfma_f32_16x16x32_bf16 v[176:179], v[16:19], v[192:195], v[176:179]
    ds_read_b128 v[188:191], v3 offset:5120
    s_cmp_lt_u32 s16, 4
    s_cbranch_scc1 K2_NG2
    s_waitcnt lgkmcnt(0)
    s_and_b32 s40, s19, 31
    s_mul_i32 s40, s40, 4
    s_and_b32 s41, s16, 3
    s_add_u32 s40, s40, s41
    s_lshl_b32 s40, s40, 7
    s_add_u32 s40, s40, 5803008
    s_mov_b32 s41, 0x8000
HO_G2:
    s_load_dword s26, s[8:9], s40 glc
    s_waitcnt lgkmcnt(0)
    s_sub_u32 s41, s41, 1
    s_cbranch_scc1 HO_G2D
    s_cmp_lg_u32 s26, 64
    s_cbranch_scc1 HO_G2
HO_G2D:
    v_mov_b32 v253, 160256
    v_mov_b32 v254, 1
    s_mov_b64 exec, 1
    ds_add_u32 v253, v254 offset:12
    s_mov_b64 exec, -1
K2_NG2:
    buffer_load_dwordx4 v[112:115], v2, s[8:11], s47 offen offset:1024
    s_waitcnt vmcnt(23) lgkmcnt(9)
    v_mfma_f32_16x16x32_bf16 v[164:167], v[20:23], v[196:199], v[164:167]
    s_waitcnt vmcnt(22)
    v_mfma_f32_16x16x32_bf16 v[172:175], v[24:27], v[196:199], v[172:175]
    ds_read_b128 v[192:195], v3 offset:25600
    buffer_load_dwordx4 v[116:119], v1, s[8:11], s47 offen offset:2048
    s_waitcnt lgkmcnt(9)
    v_mfma_f32_16x16x32_bf16 v[168:171], v[20:23], v[200:203], v[168:171]
    v_mfma_f32_16x16x32_bf16 v[176:179], v[24:27], v[200:203], v[176:179]
    ds_read_b128 v[196:199], v3 offset:6144
    buffer_load_dwordx4 v[120:123], v2, s[8:11], s47 offen offset:2048
    s_waitcnt vmcnt(23) lgkmcnt(9)
    v_mfma_f32_16x16x32_bf16 v[164:167], v[28:31], v[204:207], v[164:167]
    s_waitcnt vmcnt(22)
    v_mfma_f32_16x16x32_bf16 v[172:175], v[32:35], v[204:207], v[172:175]
    ds_read_b128 v[200:203], v3 offset:26624
    buffer_load_dwordx4 v[124:127], v1, s[8:11], s47 offen offset:3072
    s_waitcnt lgkmcnt(6)
    v_mfma_f32_16x16x32_bf16 v[168:171], v[28:31], v[208:211], v[168:171]
    v_mfma_f32_16x16x32_bf16 v[176:179], v[32:35], v[208:211], v[176:179]
    ds_read_b128 v[204:207], v3 offset:7168
    buffer_load_dwordx4 v[128:131], v2, s[8:11], s47 offen offset:3072
    s_waitcnt vmcnt(23) lgkmcnt(6)
    v_mfma_f32_16x16x32_bf16 v[164:167], v[36:39], v[180:183], v[164:167]
    s_waitcnt vmcnt(22)
    v_mfma_f32_16x16x32_bf16 v[172:175], v[40:43], v[180:183], v[172:175]
    ds_read_b128 v[208:211], v3 offset:27648
    s_add_u32 s47, s46, 16384
    buffer_load_dwordx4 v[132:135], v1, s[8:11], s47 offen offset:0
    s_waitcnt lgkmcnt(6)
    v_mfma_f32_16x16x32_bf16 v[168:171], v[36:39], v[184:187], v[168:171]
    v_mfma_f32_16x16x32_bf16 v[176:179], v[40:43], v[184:187], v[176:179]
    ds_read_b128 v[180:183], v3 offset:8192
    buffer_load_dwordx4 v[136:139], v2, s[8:11], s47 offen offset:0
    s_waitcnt vmcnt(23) lgkmcnt(6)
    v_mfma_f32_16x16x32_bf16 v[164:167], v[44:47], v[188:191], v[164:167]
    s_waitcnt vmcnt(22)
    v_mfma_f32_16x16x32_bf16 v[172:175], v[48:51], v[188:191], v[172:175]
    ds_read_b128 v[184:187], v3 offset:28672
    buffer_load_dwordx4 v[140:143], v1, s[8:11], s47 offen offset:1024
    s_waitcnt lgkmcnt(6)
    v_mfma_f32_16x16x32_bf16 v[168:171], v[44:47], v[192:195], v[168:171]
    v_mfma_f32_16x16x32_bf16 v[176:179], v[48:51], v[192:195], v[176:179]
    ds_read_b128 v[188:191], v3 offset:9216
    buffer_load_dwordx4 v[144:147], v2, s[8:11], s47 offen offset:1024
    s_waitcnt vmcnt(23) lgkmcnt(6)
    v_mfma_f32_16x16x32_bf16 v[164:167], v[52:55], v[196:199], v[164:167]
    s_waitcnt vmcnt(22)
    v_mfma_f32_16x16x32_bf16 v[172:175], v[56:59], v[196:199], v[172:175]
    ds_read_b128 v[192:195], v3 offset:29696
    s_mov_b32 s42, 0
    s_and_b32 s22, s19, 1
    s_cselect_b32 s41, -1024, 16
    s_lshl_b32 s22, s22, 1
    s_add_u32 s22, s22, s42
    s_lshl_b32 s22, s22, 9
    s_lshr_b32 s23, s19, 1
    s_cselect_b32 s41, s23, s41
    s_add_u32 s41, s41, s22
    s_min_u32 s40, s16, 4
    s_cmp_eq_u32 s16, 6
    s_cselect_b32 s40, 0, s40
    s_lshl_b32 s40, s40, 6
    v_add_u32 v253, s40, v250
    v_mul_u32_u24 v254, 6554, v253
    v_lshrrev_b32 v254, 16, v254
    v_mul_u32_u24 v255, 10, v254
    v_sub_u32 v253, v253, v255
    v_lshrrev_b32 v255, 4, v254
    v_mul_u32_u24 v255, 5120, v255
    v_lshl_add_u32 v255, v253, 9, v255
    v_and_b32 v241, 8, v254
    v_lshl_add_u32 v255, v241, 5, v255
    v_lshl_add_u32 v241, v251, 4, v255
    s_mov_b64 s[42:43], 0
    v_lshl_add_u32 v242, v254, 5, s41
    v_sub_u32 v255, 0x800, v242
    v_cmp_eq_u32 vcc, 0, v242
    v_cndmask_b32 v242, v242, v255, s[42:43]
    v_lshrrev_b32 v255, 1, v242
    v_cndmask_b32 v242, v242, v255, vcc
    v_mul_u32_u24 v242, 1280, v242
    v_lshl_add_u32 v242, v253, 4, v242
    s_mov_b64 s[42:43], -1
    v_lshl_add_u32 v243, v254, 5, s41
    v_sub_u32 v255, 0x800, v243
    v_cmp_eq_u32 vcc, 0, v243
    v_cndmask_b32 v243, v243, v255, s[42:43]
    v_lshrrev_b32 v255, 1, v243
    v_cndmask_b32 v243, v243, v255, vcc
    v_mul_u32_u24 v243, 1280, v243
    v_lshl_add_u32 v243, v253, 4, v243
    s_mul_i32 s41, s16, 10240
    s_add_u32 s41, s41, 40960
    v_lshrrev_b32 v253, 1, v252
    v_lshl_add_u32 v254, v253, 9, s41
    v_and_b32 v255, 8, v251
    v_lshl_add_u32 v254, v255, 5, v254
    v_mad_u32_u24 v253, v251, 10, v253
    v_and_b32 v255, 1, v252
    v_add_u32 v244, 0, v253
    v_and_b32 v244, 15, v244
    v_xor_b32 v244, v244, v255
    v_lshl_add_u32 v244, v244, 4, v254
    v_add_u32 v245, 2, v253
    v_and_b32 v245, 15, v245
    v_xor_b32 v245, v245, v255
    v_lshl_add_u32 v245, v245, 4, v254
    v_add_u32 v246, 4, v253
    v_and_b32 v246, 15, v246
    v_xor_b32 v246, v246, v255
    v_lshl_add_u32 v246, v246, 4, v254
    v_add_u32 v247, 6, v253
    v_and_b32 v247, 15, v247
    v_xor_b32 v247, v247, v255
    v_lshl_add_u32 v247, v247, 4, v254
    v_add_u32 v248, 8, v253
    v_and_b32 v248, 15, v248
    v_xor_b32 v248, v248, v255
    v_lshl_add_u32 v248, v248, 4, v254
    buffer_load_dwordx4 v[148:151], v1, s[8:11], s47 offen offset:2048
    s_waitcnt lgkmcnt(6)
    v_mfma_f32_16x16x32_bf16 v[168:171], v[52:55], v[200:203], v[168:171]
    v_mfma_f32_16x16x32_bf16 v[176:179], v[56:59], v[200:203], v[176:179]
    ds_read_b128 v[196:199], v3 offset:10240
    buffer_load_dwordx4 v[152:155], v2, s[8:11], s47 offen offset:2048
    s_waitcnt vmcnt(23) lgkmcnt(6)
    v_mfma_f32_16x16x32_bf16 v[164:167], v[60:63], v[204:207], v[164:167]
    s_waitcnt vmcnt(22)
    v_mfma_f32_16x16x32_bf16 v[172:175], v[64:67], v[204:207], v[172:175]
    ds_read_b128 v[200:203], v3 offset:30720
    buffer_load_dwordx4 v[156:159], v1, s[8:11], s47 offen offset:3072
    s_waitcnt lgkmcnt(6)
    v_mfma_f32_16x16x32_bf16 v[168:171], v[60:63], v[208:211], v[168:171]
    v_mfma_f32_16x16x32_bf16 v[176:179], v[64:67], v[208:211], v[176:179]
    ds_read_b128 v[204:207], v3 offset:11264
    buffer_load_dwordx4 v[160:163], v2, s[8:11], s47 offen offset:3072
    s_waitcnt vmcnt(23) lgkmcnt(6)
    v_mfma_f32_16x16x32_bf16 v[164:167], v[68:71], v[180:183], v[164:167]
    s_waitcnt vmcnt(22)
    v_mfma_f32_16x16x32_bf16 v[172:175], v[72:75], v[180:183], v[172:175]
    ds_read_b128 v[208:211], v3 offset:31744
    s_waitcnt lgkmcnt(6)
    v_mfma_f32_16x16x32_bf16 v[168:171], v[68:71], v[184:187], v[168:171]
    v_mfma_f32_16x16x32_bf16 v[176:179], v[72:75], v[184:187], v[176:179]
    ds_read_b128 v[180:183], v3 offset:12288
    s_waitcnt vmcnt(21) lgkmcnt(6)
    v_mfma_f32_16x16x32_bf16 v[164:167], v[76:79], v[188:191], v[164:167]
    s_waitcnt vmcnt(20)
    v_mfma_f32_16x16x32_bf16 v[172:175], v[80:83], v[188:191], v[172:175]
    ds_read_b128 v[184:187], v3 offset:32768
    s_waitcnt lgkmcnt(6)
    v_mfma_f32_16x16x32_bf16 v[168:171], v[76:79], v[192:195], v[168:171]
    v_mfma_f32_16x16x32_bf16 v[176:179], v[80:83], v[192:195], v[176:179]
    ds_read_b128 v[188:191], v3 offset:13312
    s_waitcnt vmcnt(19) lgkmcnt(6)
    v_mfma_f32_16x16x32_bf16 v[164:167], v[84:87], v[196:199], v[164:167]
    s_waitcnt vmcnt(18)
    v_mfma_f32_16x16x32_bf16 v[172:175], v[88:91], v[196:199], v[172:175]
    ds_read_b128 v[192:195], v3 offset:33792
    s_waitcnt lgkmcnt(6)
    v_mfma_f32_16x16x32_bf16 v[168:171], v[84:87], v[200:203], v[168:171]
    v_mfma_f32_16x16x32_bf16 v[176:179], v[88:91], v[200:203], v[176:179]
    ds_read_b128 v[196:199], v3 offset:14336
    s_waitcnt vmcnt(17) lgkmcnt(6)
    v_mfma_f32_16x16x32_bf16 v[164:167], v[92:95], v[204:207], v[164:167]
    s_waitcnt vmcnt(16)
    v_mfma_f32_16x16x32_bf16 v[172:175], v[96:99], v[204:207], v[172:175]
    ds_read_b128 v[200:203], v3 offset:34816
    s_waitcnt lgkmcnt(6)
    v_mfma_f32_16x16x32_bf16 v[168:171], v[92:95], v[208:211], v[168:171]
    v_mfma_f32_16x16x32_bf16 v[176:179], v[96:99], v[208:211], v[176:179]
    ds_read_b128 v[204:207], v3 offset:15360
    s_waitcnt vmcnt(15) lgkmcnt(6)
    v_mfma_f32_16x16x32_bf16 v[164:167], v[100:103], v[180:183], v[164:167]
    s_waitcnt vmcnt(14)
    v_mfma_f32_16x16x32_bf16 v[172:175], v[104:107], v[180:183], v[172:175]
    ds_read_b128 v[208:211], v3 offset:35840
    v_mov_b32 v253, 160256
K2_W2R:
    ds_read_b32 v254, v253 offset:12
    s_waitcnt lgkmcnt(0)
    v_cmp_ne_u32 vcc, 4, v254
    s_cbranch_vccnz K2_W2R
    s_mul_i32 s28, s16, 10240
    s_add_u32 s28, s28, 71680
    s_mul_i32 s29, s97, 5120
    s_add_u32 s29, s29, s100
    s_add_u32 m0, s28, 0
    s_nop 0
    buffer_load_dwordx4 v1, s[8:11], s29 offen offset:0 lds
    v_mfma_f32_16x16x32_bf16 v[168:171], v[100:103], v[184:187], v[168:171]
    v_mfma_f32_16x16x32_bf16 v[176:179], v[104:107], v[184:187], v[176:179]
    ds_read_b128 v[180:183], v3 offset:16384
    buffer_load_dwordx4 v1, s[8:11], s29 offen offset:1024 lds
    s_waitcnt vmcnt(15)
    v_mfma_f32_16x16x32_bf16 v[164:167], v[108:111], v[188:191], v[164:167]
    s_waitcnt vmcnt(14)
    v_mfma_f32_16x16x32_bf16 v[172:175], v[112:115], v[188:191], v[172:175]
    ds_read_b128 v[184:187], v3 offset:36864
    buffer_load_dwordx4 v1, s[8:11], s29 offen offset:2048 lds
    v_mfma_f32_16x16x32_bf16 v[168:171], v[108:111], v[192:195], v[168:171]
    v_mfma_f32_16x16x32_bf16 v[176:179], v[112:115], v[192:195], v[176:179]
    ds_read_b128 v[188:191], v3 offset:17408
    buffer_load_dwordx4 v1, s[8:11], s29 offen offset:3072 lds
    s_waitcnt vmcnt(15)
    v_mfma_f32_16x16x32_bf16 v[164:167], v[116:119], v[196:199], v[164:167]
    s_waitcnt vmcnt(14)
    v_mfma_f32_16x16x32_bf16 v[172:175], v[120:123], v[196:199], v[172:175]
    ds_read_b128 v[192:195], v3 offset:37888
    s_add_u32 s29, s29, 4096
    s_add_u32 m0, s28, 4096
    s_nop 0
    buffer_load_dwordx4 v1, s[8:11], s29 offen offset:0 lds
    v_mfma_f32_16x16x32_bf16 v[168:171], v[116:119], v[200:203], v[168:171]
    v_mfma_f32_16x16x32_bf16 v[176:179], v[120:123], v[200:203], v[176:179]
    ds_read_b128 v[196:199], v3 offset:18432
    s_mul_i32 s29, s98, 5120
    s_add_u32 s29, s29, s100
    s_add_u32 m0, s28, 5120
    s_nop 0
    buffer_load_dwordx4 v1, s[8:11], s29 offen offset:0 lds
    s_waitcnt vmcnt(15)
    v_mfma_f32_16x16x32_bf16 v[164:167], v[124:127], v[204:207], v[164:167]
    s_waitcnt vmcnt(14)
    v_mfma_f32_16x16x32_bf16 v[172:175], v[128:131], v[204:207], v[172:175]
    ds_read_b128 v[200:203], v3 offset:38912
    buffer_load_dwordx4 v1, s[8:11], s29 offen offset:1024 lds
    v_mfma_f32_16x16x32_bf16 v[168:171], v[124:127], v[208:211], v[168:171]
    v_mfma_f32_16x16x32_bf16 v[176:179], v[128:131], v[208:211], v[176:179]
    ds_read_b128 v[204:207], v3 offset:19456
    buffer_load_dwordx4 v1, s[8:11], s29 offen offset:2048 lds
    s_waitcnt vmcnt(15) lgkmcnt(6)
    v_mfma_f32_16x16x32_bf16 v[164:167], v[132:135], v[180:183], v[164:167]
    s_waitcnt vmcnt(14)
    v_mfma_f32_16x16x32_bf16 v[172:175], v[136:139], v[180:183], v[172:175]
    ds_read_b128 v[208:211], v3 offset:39936
    buffer_load_dwordx4 v1, s[8:11], s29 offen offset:3072 lds
    s_waitcnt lgkmcnt(6)
    v_mfma_f32_16x16x32_bf16 v[168:171], v[132:135], v[184:187], v[168:171]
    v_mfma_f32_16x16x32_bf16 v[176:179], v[136:139], v[184:187], v[176:179]
    s_add_u32 s29, s29, 4096
    s_add_u32 m0, s28, 9216
    s_nop 0
    buffer_load_dwordx4 v1, s[8:11], s29 offen offset:0 lds
    s_waitcnt vmcnt(15) lgkmcnt(5)
    v_mfma_f32_16x16x32_bf16 v[164:167], v[140:143], v[188:191], v[164:167]
    s_waitcnt vmcnt(14)
    v_mfma_f32_16x16x32_bf16 v[172:175], v[144:147], v[188:191], v[172:175]
    s_waitcnt lgkmcnt(4)
    v_mfma_f32_16x16x32_bf16 v[168:171], v[140:143], v[192:195], v[168:171]
    v_mfma_f32_16x16x32_bf16 v[176:179], v[144:147], v[192:195], v[176:179]
    s_waitcnt vmcnt(13) lgkmcnt(3)
    v_mfma_f32_16x16x32_bf16 v[164:167], v[148:151], v[196:199], v[164:167]
    s_waitcnt vmcnt(12)
    v_mfma_f32_16x16x32_bf16 v[172:175], v[152:155], v[196:199], v[172:175]
    s_waitcnt lgkmcnt(2)
    v_mfma_f32_16x16x32_bf16 v[168:171], v[148:151], v[200:203], v[168:171]
    v_mfma_f32_16x16x32_bf16 v[176:179], v[152:155], v[200:203], v[176:179]
    s_waitcnt vmcnt(11) lgkmcnt(1)
    v_mfma_f32_16x16x32_bf16 v[164:167], v[156:159], v[204:207], v[164:167]
    s_waitcnt vmcnt(10)
    v_mfma_f32_16x16x32_bf16 v[172:175], v[160:163], v[204:207], v[172:175]
    s_waitcnt lgkmcnt(0)
    v_mfma_f32_16x16x32_bf16 v[168:171], v[156:159], v[208:211], v[168:171]
    v_mfma_f32_16x16x32_bf16 v[176:179], v[160:163], v[208:211], v[176:179]
    ds_read_b128 v[180:183], v1 offset:0
    ds_read_b128 v[184:187], v1 offset:20480
    ds_read_b128 v[188:191], v1 offset:1024
    ds_read_b128 v[192:195], v1 offset:21504
    ds_read_b128 v[196:199], v1 offset:2048
    ds_read_b128 v[200:203], v1 offset:22528
    ds_read_b128 v[204:207], v1 offset:3072
    v_mov_b32 v253, 160256
K2_SW0:
    ds_read_b32 v254, v253 offset:4
    s_waitcnt lgkmcnt(0)
    v_cmp_ne_u32 vcc, 1, v254
    s_cbranch_vccnz K2_SW0
    v_lshlrev_b32 v253, 3, v251
    v_add_u32 v253, 159744, v253
    ds_read_b64 v[236:237], v253 offset:0
    ds_read_b64 v[238:239], v253 offset:128
    s_lshl_b32 s40, s44, 11
    s_add_u32 s40, s40, s101
    s_waitcnt lgkmcnt(1)
    v_fmac_f32 v164, v236, v220
    v_fmac_f32 v165, v236, v221
    v_fmac_f32 v166, v236, v222
    v_fmac_f32 v167, v236, v223
    v_fma_f32 v164, v164, v237, v224
    v_fma_f32 v165, v165, v237, v225
    v_fma_f32 v166, v166, v237, v226
    v_fma_f32 v167, v167, v237, v227
    v_max_f32 v164, 0, v164
    v_max_f32 v165, 0, v165
    v_max_f32 v166, 0, v166
    v_max_f32 v167, 0, v167
    v_mul_f32 v164, v164, v164
    v_mul_f32 v165, v165, v165
    v_mul_f32 v166, v166, v166
    v_mul_f32 v167, v167, v167
    v_cvt_pk_bf16_f32 v212, v164, v165
    v_cvt_pk_bf16_f32 v213, v166, v167
    v_fmac_f32 v172, v236, v232
    v_fmac_f32 v173, v236, v233
    v_fmac_f32 v174, v236, v234
    v_fmac_f32 v175, v236, v235
    v_fma_f32 v172, v172, v237, v228
    v_fma_f32 v173, v173, v237, v229
    v_fma_f32 v174, v174, v237, v230
    v_fma_f32 v175, v175, v237, v231
    v_max_f32 v172, 0, v172
    v_max_f32 v173, 0, v173
    v_max_f32 v174, 0, v174
    v_max_f32 v175, 0, v175
    v_mul_f32 v172, v172, v172
    v_mul_f32 v173, v173, v173
    v_mul_f32 v174, v174, v174
    v_mul_f32 v175, v175, v175
    v_cvt_pk_bf16_f32 v214, v172, v173
    v_cvt_pk_bf16_f32 v215, v174, v175
    buffer_store_dwordx4 v[212:215], v1, s[8:11], s40 offen offset:0 sc0 sc1
    s_waitcnt lgkmcnt(0)
    v_fmac_f32 v168, v238, v220
    v_fmac_f32 v169, v238, v221
    v_fmac_f32 v170, v238, v222
    v_fmac_f32 v171, v238, v223
    v_fma_f32 v168, v168, v239, v224
    v_fma_f32 v169, v169, v239, v225
    v_fma_f32 v170, v170, v239, v226
    v_fma_f32 v171, v171, v239, v227
    v_max_f32 v168, 0, v168
    v_max_f32 v169, 0, v169
    v_max_f32 v170, 0, v170
    v_max_f32 v171, 0, v171
    v_mul_f32 v168, v168, v168
    v_mul_f32 v169, v169, v169
    v_mul_f32 v170, v170, v170
    v_mul_f32 v171, v171, v171
    v_cvt_pk_bf16_f32 v216, v168, v169
    v_cvt_pk_bf16_f32 v217, v170, v171
    v_fmac_f32 v176, v238, v232
    v_fmac_f32 v177, v238, v233
    v_fmac_f32 v178, v238, v234
    v_fmac_f32 v179, v238, v235
    v_fma_f32 v176, v176, v239, v228
    v_fma_f32 v177, v177, v239, v229
    v_fma_f32 v178, v178, v239, v230
    v_fma_f32 v179, v179, v239, v231
    v_max_f32 v176, 0, v176
    v_max_f32 v177, 0, v177
    v_max_f32 v178, 0, v178
    v_max_f32 v179, 0, v179
    v_mul_f32 v176, v176, v176
    v_mul_f32 v177, v177, v177
    v_mul_f32 v178, v178, v178
    v_mul_f32 v179, v179, v179
    v_cvt_pk_bf16_f32 v218, v176, v177
    v_cvt_pk_bf16_f32 v219, v178, v179
    buffer_store_dwordx4 v[216:219], v1, s[8:11], s40 offen offset:1024 sc0 sc1
    s_setprio 2
    v_add_u32 v2, 4096, v1
    v_mfma_f32_16x16x32_bf16 v[164:167], v[4:7], v[180:183], 0
    v_mfma_f32_16x16x32_bf16 v[172:175], v[8:11], v[180:183], 0
    ds_read_b128 v[208:211], v1 offset:23552
    v_mfma_f32_16x16x32_bf16 v[168:171], v[4:7], v[184:187], 0
    v_mfma_f32_16x16x32_bf16 v[176:179], v[8:11], v[184:187], 0
    ds_read_b128 v[180:183], v1 offset:4096
    v_mfma_f32_16x16x32_bf16 v[164:167], v[12:15], v[188:191], v[164:167]
    v_mfma_f32_16x16x32_bf16 v[172:175], v[16:19], v[188:191], v[172:175]
    ds_read_b128 v[184:187], v1 offset:24576
    s_mul_i32 s57, s92, 5120
    s_add_u32 s57, s57, s100
    buffer_load_dwordx4 v[4:7], v1, s[8:11], s57 offen offset:0
    v_mfma_f32_16x16x32_bf16 v[168:171], v[12:15], v[192:195], v[168:171]
    v_mfma_f32_16x16x32_bf16 v[176:179], v[16:19], v[192:195], v[176:179]
    ds_read_b128 v[188:191], v1 offset:5120
    v_mfma_f32_16x16x32_bf16 v[164:167], v[20:23], v[196:199], v[164:167]
    v_mfma_f32_16x16x32_bf16 v[172:175], v[24:27], v[196:199], v[172:175]
    ds_read_b128 v[192:195], v1 offset:25600
    buffer_load_dwordx4 v[8:11], v1, s[8:11], s57 offen offset:1024
    v_mfma_f32_16x16x32_bf16 v[168:171], v[20:23], v[200:203], v[168:171]
    v_mfma_f32_16x16x32_bf16 v[176:179], v[24:27], v[200:203], v[176:179]
    ds_read_b128 v[196:199], v1 offset:6144
    v_mfma_f32_16x16x32_bf16 v[164:167], v[28:31], v[204:207], v[164:167]
    v_mfma_f32_16x16x32_bf16 v[172:175], v[32:35], v[204:207], v[172:175]
    ds_read_b128 v[200:203], v1 offset:26624
    buffer_load_dwordx4 v[12:15], v1, s[8:11], s57 offen offset:2048
    s_waitcnt lgkmcnt(6)
    v_mfma_f32_16x16x32_bf16 v[168:171], v[28:31], v[208:211], v[168:171]
    v_mfma_f32_16x16x32_bf16 v[176:179], v[32:35], v[208:211], v[176:179]
    ds_read_b128 v[204:207], v1 offset:7168
    s_waitcnt lgkmcnt(6)
    v_mfma_f32_16x16x32_bf16 v[164:167], v[36:39], v[180:183], v[164:167]
    v_mfma_f32_16x16x32_bf16 v[172:175], v[40:43], v[180:183], v[172:175]
    ds_read_b128 v[208:211], v1 offset:27648
    buffer_load_dwordx4 v[16:19], v1, s[8:11], s57 offen offset:3072
    s_waitcnt lgkmcnt(6)
    v_mfma_f32_16x16x32_bf16 v[168:171], v[36:39], v[184:187], v[168:171]
    v_mfma_f32_16x16x32_bf16 v[176:179], v[40:43], v[184:187], v[176:179]
    ds_read_b128 v[180:183], v1 offset:8192
    s_waitcnt lgkmcnt(6)
    v_mfma_f32_16x16x32_bf16 v[164:167], v[44:47], v[188:191], v[164:167]
    v_mfma_f32_16x16x32_bf16 v[172:175], v[48:51], v[188:191], v[172:175]
    ds_read_b128 v[184:187], v1 offset:28672
    buffer_load_dwordx4 v[20:23], v2, s[8:11], s57 offen offset:0
    s_waitcnt lgkmcnt(6)
    v_mfma_f32_16x16x32_bf16 v[168:171], v[44:47], v[192:195], v[168:171]
    v_mfma_f32_16x16x32_bf16 v[176:179], v[48:51], v[192:195], v[176:179]
    ds_read_b128 v[188:191], v1 offset:9216
    s_waitcnt lgkmcnt(6)
    v_mfma_f32_16x16x32_bf16 v[164:167], v[52:55], v[196:199], v[164:167]
    v_mfma_f32_16x16x32_bf16 v[172:175], v[56:59], v[196:199], v[172:175]
    ds_read_b128 v[192:195], v1 offset:29696
    s_mul_i32 s57, s93, 5120
    s_add_u32 s57, s57, s100
    buffer_load_dwordx4 v[24:27], v1, s[8:11], s57 offen offset:0
    s_waitcnt lgkmcnt(6)
    v_mfma_f32_16x16x32_bf16 v[168:171], v[52:55], v[200:203], v[168:171]
    v_mfma_f32_16x16x32_bf16 v[176:179], v[56:59], v[200:203], v[176:179]
    ds_read_b128 v[196:199], v1 offset:10240
    s_waitcnt lgkmcnt(6)
    v_mfma_f32_16x16x32_bf16 v[164:167], v[60:63], v[204:207], v[164:167]
    v_mfma_f32_16x16x32_bf16 v[172:175], v[64:67], v[204:207], v[172:175]
    ds_read_b128 v[200:203], v1 offset:30720
    s_waitcnt vmcnt(6)
    v_mov_b32 v253, s91
    v_writelane_b32 v253, s17, 1
    v_mov_b32 v254, 1
    s_mov_b64 exec, 3
    buffer_store_dword v254, v253, s[8:11], s99 offen offset:0 sc0 sc1
    s_mov_b64 exec, -1
    buffer_load_dwordx4 v[28:31], v1, s[8:11], s57 offen offset:1024
    s_waitcnt lgkmcnt(6)
    v_mfma_f32_16x16x32_bf16 v[168:171], v[60:63], v[208:211], v[168:171]
    v_mfma_f32_16x16x32_bf16 v[176:179], v[64:67], v[208:211], v[176:179]
    ds_read_b128 v[204:207], v1 offset:11264
    s_waitcnt lgkmcnt(6)
    v_mfma_f32_16x16x32_bf16 v[164:167], v[68:71], v[180:183], v[164:167]
    v_mfma_f32_16x16x32_bf16 v[172:175], v[72:75], v[180:183], v[172:175]
    ds_read_b128 v[208:211], v1 offset:31744
    buffer_load_dwordx4 v[32:35], v1, s[8:11], s57 offen offset:2048
    s_waitcnt lgkmcnt(6)
    v_mfma_f32_16x16x32_bf16 v[168:171], v[68:71], v[184:187], v[168:171]
    v_mfma_f32_16x16x32_bf16 v[176:179], v[72:75], v[184:187], v[176:179]
    ds_read_b128 v[180:183], v1 offset:12288
    s_waitcnt lgkmcnt(6)
    v_mfma_f32_16x16x32_bf16 v[164:167], v[76:79], v[188:191], v[164:167]
    v_mfma_f32_16x16x32_bf16 v[172:175], v[80:83], v[188:191], v[172:175]
    ds_read_b128 v[184:187], v1 offset:32768
    buffer_load_dwordx4 v[36:39], v1, s[8:11], s57 offen offset:3072
    s_waitcnt lgkmcnt(6)
    v_mfma_f32_16x16x32_bf16 v[168:171], v[76:79], v[192:195], v[168:171]
    v_mfma_f32_16x16x32_bf16 v[176:179], v[80:83], v[192:195], v[176:179]
    ds_read_b128 v[188:191], v1 offset:13312
    s_waitcnt lgkmcnt(6)
    v_mfma_f32_16x16x32_bf16 v[164:167], v[84:87], v[196:199], v[164:167]
    v_mfma_f32_16x16x32_bf16 v[172:175], v[88:91], v[196:199], v[172:175]
    ds_read_b128 v[192:195], v1 offset:33792
    buffer_load_dwordx4 v[40:43], v2, s[8:11], s57 offen offset:0
    s_waitcnt lgkmcnt(6)
    v_mfma_f32_16x16x32_bf16 v[168:171], v[84:87], v[200:203], v[168:171]
    v_mfma_f32_16x16x32_bf16 v[176:179], v[88:91], v[200:203], v[176:179]
    ds_read_b128 v[196:199], v1 offset:14336
    s_waitcnt lgkmcnt(6)
    v_mfma_f32_16x16x32_bf16 v[164:167], v[92:95], v[204:207], v[164:167]
    v_mfma_f32_16x16x32_bf16 v[172:175], v[96:99], v[204:207], v[172:175]
    ds_read_b128 v[200:203], v1 offset:34816
    s_mul_i32 s57, s94, 5120
    s_add_u32 s57, s57, s100
    buffer_load_dwordx4 v[44:47], v1, s[8:11], s57 offen offset:0
    s_waitcnt lgkmcnt(6)
    v_mfma_f32_16x16x32_bf16 v[168:171], v[92:95], v[208:211], v[168:171]
    v_mfma_f32_16x16x32_bf16 v[176:179], v[96:99], v[208:211], v[176:179]
    ds_read_b128 v[204:207], v1 offset:15360
    s_waitcnt lgkmcnt(6)
    v_mfma_f32_16x16x32_bf16 v[164:167], v[100:103], v[180:183], v[164:167]
    v_mfma_f32_16x16x32_bf16 v[172:175], v[104:107], v[180:183], v[172:175]
    ds_read_b128 v[208:211], v1 offset:35840
    buffer_load_dwordx4 v[48:51], v1, s[8:11], s57 offen offset:1024
    s_waitcnt lgkmcnt(6)
    v_mfma_f32_16x16x32_bf16 v[168:171], v[100:103], v[184:187], v[168:171]
    v_mfma_f32_16x16x32_bf16 v[176:179], v[104:107], v[184:187], v[176:179]
    ds_read_b128 v[180:183], v1 offset:16384
    s_waitcnt lgkmcnt(6)
    v_mfma_f32_16x16x32_bf16 v[164:167], v[108:111], v[188:191], v[164:167]
    v_mfma_f32_16x16x32_bf16 v[172:175], v[112:115], v[188:191], v[172:175]
    ds_read_b128 v[184:187], v1 offset:36864
    buffer_load_dwordx4 v[52:55], v1, s[8:11], s57 offen offset:2048
    s_waitcnt lgkmcnt(6)
    v_mfma_f32_16x16x32_bf16 v[168:171], v[108:111], v[192:195], v[168:171]
    v_mfma_f32_16x16x32_bf16 v[176:179], v[112:115], v[192:195], v[176:179]
    ds_read_b128 v[188:191], v1 offset:17408
    s_waitcnt lgkmcnt(6)
    v_mfma_f32_16x16x32_bf16 v[164:167], v[116:119], v[196:199], v[164:167]
    v_mfma_f32_16x16x32_bf16 v[172:175], v[120:123], v[196:199], v[172:175]
    ds_read_b128 v[192:195], v1 offset:37888
    buffer_load_dwordx4 v[56:59], v1, s[8:11], s57 offen offset:3072
    s_waitcnt lgkmcnt(6)
    v_mfma_f32_16x16x32_bf16 v[168:171], v[116:119], v[200:203], v[168:171]
    v_mfma_f32_16x16x32_bf16 v[176:179], v[120:123], v[200:203], v[176:179]
    ds_read_b128 v[196:199], v1 offset:18432
    s_waitcnt lgkmcnt(6)
    v_mfma_f32_16x16x32_bf16 v[164:167], v[124:127], v[204:207], v[164:167]
    v_mfma_f32_16x16x32_bf16 v[172:175], v[128:131], v[204:207], v[172:175]
    ds_read_b128 v[200:203], v1 offset:38912
    buffer_load_dwordx4 v[60:63], v2, s[8:11], s57 offen offset:0
    s_waitcnt lgkmcnt(6)
    v_mfma_f32_16x16x32_bf16 v[168:171], v[124:127], v[208:211], v[168:171]
    v_mfma_f32_16x16x32_bf16 v[176:179], v[128:131], v[208:211], v[176:179]
    ds_read_b128 v[204:207], v1 offset:19456
    s_waitcnt lgkmcnt(6)
    v_mfma_f32_16x16x32_bf16 v[164:167], v[132:135], v[180:183], v[164:167]
    v_mfma_f32_16x16x32_bf16 v[172:175], v[136:139], v[180:183], v[172:175]
    ds_read_b128 v[208:211], v1 offset:39936
    s_mul_i32 s57, s95, 5120
    s_add_u32 s57, s57, s100
    buffer_load_dwordx4 v[64:67], v1, s[8:11], s57 offen offset:0
    s_waitcnt lgkmcnt(6)
    v_mfma_f32_16x16x32_bf16 v[168:171], v[132:135], v[184:187], v[168:171]
    v_mfma_f32_16x16x32_bf16 v[176:179], v[136:139], v[184:187], v[176:179]
    s_waitcnt lgkmcnt(0)
    s_load_dwordx8 s[32:39], s[8:9], s90 glc
    v_mfma_f32_16x16x32_bf16 v[164:167], v[140:143], v[188:191], v[164:167]
    v_mfma_f32_16x16x32_bf16 v[172:175], v[144:147], v[188:191], v[172:175]
    buffer_load_dwordx4 v[68:71], v1, s[8:11], s57 offen offset:1024
    v_mfma_f32_16x16x32_bf16 v[168:171], v[140:143], v[192:195], v[168:171]
    v_mfma_f32_16x16x32_bf16 v[176:179], v[144:147], v[192:195], v[176:179]
    v_mfma_f32_16x16x32_bf16 v[164:167], v[148:151], v[196:199], v[164:167]
    v_mfma_f32_16x16x32_bf16 v[172:175], v[152:155], v[196:199], v[172:175]
    buffer_load_dwordx4 v[72:75], v1, s[8:11], s57 offen offset:2048
    v_mfma_f32_16x16x32_bf16 v[168:171], v[148:151], v[200:203], v[168:171]
    v_mfma_f32_16x16x32_bf16 v[176:179], v[152:155], v[200:203], v[176:179]
    v_mfma_f32_16x16x32_bf16 v[164:167], v[156:159], v[204:207], v[164:167]
    v_mfma_f32_16x16x32_bf16 v[172:175], v[160:163], v[204:207], v[172:175]
    buffer_load_dwordx4 v[76:79], v1, s[8:11], s57 offen offset:3072
    v_mfma_f32_16x16x32_bf16 v[168:171], v[156:159], v[208:211], v[168:171]
    v_mfma_f32_16x16x32_bf16 v[176:179], v[160:163], v[208:211], v[176:179]
    s_mov_b32 s41, 0x8000
K2_PSa0:
    s_waitcnt lgkmcnt(0)
    s_and_b64 s[32:33], s[32:33], s[38:39]
    s_and_b64 s[34:35], s[34:35], s[36:37]
    s_and_b64 s[32:33], s[32:33], s[34:35]
    s_and_b32 s33, s33, s32
    s_cbranch_scc1 K2_PDa0
    s_load_dwordx8 s[32:39], s[8:9], s90 glc
    s_sub_u32 s41, s41, 1
    s_cbranch_scc0 K2_PSa0
    s_waitcnt lgkmcnt(0)
K2_PDa0:
    v_add_u32 v255, s28, v1
    ds_read_b128 v[104:107], v255 offset:0
    ds_read_b128 v[108:111], v255 offset:1024
    ds_read_b128 v[112:115], v255 offset:2048
    ds_read_b128 v[116:119], v255 offset:3072
    ds_read_b128 v[120:123], v255 offset:4096
    ds_read_b128 v[124:127], v255 offset:5120
    ds_read_b128 v[128:131], v255 offset:6144
    ds_read_b128 v[132:135], v255 offset:7168
    ds_read_b128 v[136:139], v255 offset:8192
    ds_read_b128 v[140:143], v255 offset:9216
    v_mov_b32 v253, 160256
K2_SW1:
    ds_read_b32 v254, v253 offset:8
    s_waitcnt lgkmcnt(0)
    v_cmp_ne_u32 vcc, 1, v254
    s_cbranch_vccnz K2_SW1
    v_lshlrev_b32 v253, 3, v251
    v_add_u32 v253, 159744, v253
    ds_read_b64 v[236:237], v253 offset:256
    ds_read_b64 v[238:239], v253 offset:384
    s_lshl_b32 s40, s44, 11
    s_add_u32 s40, s40, s101
    s_add_u32 s40, s40, 110592
    s_waitcnt lgkmcnt(1)
    v_fmac_f32 v164, v236, v220
    v_fmac_f32 v165, v236, v221
    v_fmac_f32 v166, v236, v222
    v_fmac_f32 v167, v236, v223
    v_fma_f32 v164, v164, v237, v224
    v_fma_f32 v165, v165, v237, v225
    v_fma_f32 v166, v166, v237, v226
    v_fma_f32 v167, v167, v237, v227
    v_max_f32 v164, 0, v164
    v_max_f32 v165, 0, v165
    v_max_f32 v166, 0, v166
    v_max_f32 v167, 0, v167
    v_mul_f32 v164, v164, v164
    v_mul_f32 v165, v165, v165
    v_mul_f32 v166, v166, v166
    v_mul_f32 v167, v167, v167
    v_cvt_pk_bf16_f32 v180, v164, v165
    v_cvt_pk_bf16_f32 v181, v166, v167
    v_fmac_f32 v172, v236, v232
    v_fmac_f32 v173, v236, v233
    v_fmac_f32 v174, v236, v234
    v_fmac_f32 v175, v236, v235
    v_fma_f32 v172, v172, v237, v228
    v_fma_f32 v173, v173, v237, v229
    v_fma_f32 v174, v174, v237, v230
    v_fma_f32 v175, v175, v237, v231
    v_max_f32 v172, 0, v172
    v_max_f32 v173, 0, v173
    v_max_f32 v174, 0, v174
    v_max_f32 v175, 0, v175
    v_mul_f32 v172, v172, v172
    v_mul_f32 v173, v173, v173
    v_mul_f32 v174, v174, v174
    v_mul_f32 v175, v175, v175
    v_cvt_pk_bf16_f32 v182, v172, v173
    v_cvt_pk_bf16_f32 v183, v174, v175
    buffer_store_dwordx4 v[180:183], v1, s[8:11], s40 offen offset:0 sc0 sc1
    s_waitcnt lgkmcnt(0)
    v_fmac_f32 v168, v238, v220
    v_fmac_f32 v169, v238, v221
    v_fmac_f32 v170, v238, v222
    v_fmac_f32 v171, v238, v223
    v_fma_f32 v168, v168, v239, v224
    v_fma_f32 v169, v169, v239, v225
    v_fma_f32 v170, v170, v239, v226
    v_fma_f32 v171, v171, v239, v227
    v_max_f32 v168, 0, v168
    v_max_f32 v169, 0, v169
    v_max_f32 v170, 0, v170
    v_max_f32 v171, 0, v171
    v_mul_f32 v168, v168, v168
    v_mul_f32 v169, v169, v169
    v_mul_f32 v170, v170, v170
    v_mul_f32 v171, v171, v171
    v_cvt_pk_bf16_f32 v184, v168, v169
    v_cvt_pk_bf16_f32 v185, v170, v171
    v_fmac_f32 v176, v238, v232
    v_fmac_f32 v177, v238, v233
    v_fmac_f32 v178, v238, v234
    v_fmac_f32 v179, v238, v235
    v_fma_f32 v176, v176, v239, v228
    v_fma_f32 v177, v177, v239, v229
    v_fma_f32 v178, v178, v239, v230
    v_fma_f32 v179, v179, v239, v231
    v_max_f32 v176, 0, v176
    v_max_f32 v177, 0, v177
    v_max_f32 v178, 0, v178
    v_max_f32 v179, 0, v179
    v_mul_f32 v176, v176, v176
    v_mul_f32 v177, v177, v177
    v_mul_f32 v178, v178, v178
    v_mul_f32 v179, v179, v179
    v_cvt_pk_bf16_f32 v186, v176, v177
    v_cvt_pk_bf16_f32 v187, v178, v179
    buffer_store_dwordx4 v[184:187], v1, s[8:11], s40 offen offset:1024 sc0 sc1
    v_mov_b32 v253, 160256
    v_mov_b32 v254, 1
    s_mov_b64 exec, 1
    ds_add_u32 v253, v254
    s_mov_b64 exec, -1
    s_lshl_b32 s56, s93, 11
    s_add_u32 s56, s56, s101
    buffer_load_dwordx4 v[188:191], v1, s[8:11], s56 offen offset:0 sc1
    buffer_load_dwordx4 v[192:195], v1, s[8:11], s56 offen offset:1024 sc1
    s_lshl_b32 s56, s94, 11
    s_add_u32 s56, s56, s101
    buffer_load_dwordx4 v[196:199], v1, s[8:11], s56 offen offset:0 sc1
    buffer_load_dwordx4 v[200:203], v1, s[8:11], s56 offen offset:1024 sc1
    buffer_load_dwordx4 v[80:83], v2, s[8:11], s57 offen offset:0
    s_lshl_b32 s56, s95, 11
    s_add_u32 s56, s56, s101
    buffer_load_dwordx4 v[204:207], v1, s[8:11], s56 offen offset:0 sc1
    buffer_load_dwordx4 v[208:211], v1, s[8:11], s56 offen offset:1024 sc1
    s_mul_i32 s57, s96, 5120
    s_add_u32 s57, s57, s100
    buffer_load_dwordx4 v[84:87], v1, s[8:11], s57 offen offset:0
    s_waitcnt vmcnt(8)
    v_mov_b32 v253, s91
    v_writelane_b32 v253, s17, 1
    v_mov_b32 v254, 1
    s_mov_b64 exec, 3
    buffer_store_dword v254, v253, s[8:11], s99 offen offset:64 sc0 sc1
    s_mov_b64 exec, -1
    buffer_load_dwordx4 v[88:91], v1, s[8:11], s57 offen offset:1024
    buffer_load_dwordx4 v[92:95], v1, s[8:11], s57 offen offset:2048
    buffer_load_dwordx4 v[96:99], v1, s[8:11], s57 offen offset:3072
    buffer_load_dwordx4 v[100:103], v2, s[8:11], s57 offen offset:0
    s_lshl_b32 s56, s96, 11
    s_add_u32 s56, s56, s101
    buffer_load_dwordx4 v[152:155], v1, s[8:11], s56 offen offset:0 sc1
    buffer_load_dwordx4 v[156:159], v1, s[8:11], s56 offen offset:1024 sc1
    s_setprio 1
    v_mfma_f32_16x16x32_bf16 v[164:167], v[4:7], v[212:215], 0
    v_mfma_f32_16x16x32_bf16 v[168:171], v[8:11], v[212:215], 0
    v_mfma_f32_16x16x32_bf16 v[172:175], v[12:15], v[212:215], 0
    v_mfma_f32_16x16x32_bf16 v[176:179], v[16:19], v[212:215], 0
    v_mfma_f32_16x16x32_bf16 v[220:223], v[20:23], v[212:215], 0
    v_mfma_f32_16x16x32_bf16 v[224:227], v[4:7], v[216:219], 0
    v_mfma_f32_16x16x32_bf16 v[228:231], v[8:11], v[216:219], 0
    v_mfma_f32_16x16x32_bf16 v[232:235], v[12:15], v[216:219], 0
    v_mfma_f32_16x16x32_bf16 v[144:147], v[16:19], v[216:219], 0
    v_mfma_f32_16x16x32_bf16 v[148:151], v[20:23], v[216:219], 0
    s_lshl_b32 s56, s97, 11
    s_add_u32 s56, s56, s101
    buffer_load_dwordx4 v[212:215], v1, s[8:11], s56 offen offset:0 sc1
    buffer_load_dwordx4 v[216:219], v1, s[8:11], s56 offen offset:1024 sc1
    s_waitcnt vmcnt(16)
    v_mfma_f32_16x16x32_bf16 v[164:167], v[24:27], v[188:191], v[164:167]
    v_mfma_f32_16x16x32_bf16 v[168:171], v[28:31], v[188:191], v[168:171]
    v_mfma_f32_16x16x32_bf16 v[172:175], v[32:35], v[188:191], v[172:175]
    v_mfma_f32_16x16x32_bf16 v[176:179], v[36:39], v[188:191], v[176:179]
    v_mfma_f32_16x16x32_bf16 v[220:223], v[40:43], v[188:191], v[220:223]
    s_waitcnt vmcnt(15)
    v_mfma_f32_16x16x32_bf16 v[224:227], v[24:27], v[192:195], v[224:227]
    v_mfma_f32_16x16x32_bf16 v[228:231], v[28:31], v[192:195], v[228:231]
    v_mfma_f32_16x16x32_bf16 v[232:235], v[32:35], v[192:195], v[232:235]
    v_mfma_f32_16x16x32_bf16 v[144:147], v[36:39], v[192:195], v[144:147]
    v_mfma_f32_16x16x32_bf16 v[148:151], v[40:43], v[192:195], v[148:151]
    s_lshl_b32 s56, s98, 11
    s_add_u32 s56, s56, s101
    buffer_load_dwordx4 v[188:191], v1, s[8:11], s56 offen offset:0 sc1
    buffer_load_dwordx4 v[192:195], v1, s[8:11], s56 offen offset:1024 sc1
    s_waitcnt vmcnt(16)
    v_mfma_f32_16x16x32_bf16 v[164:167], v[44:47], v[196:199], v[164:167]
    v_mfma_f32_16x16x32_bf16 v[168:171], v[48:51], v[196:199], v[168:171]
    v_mfma_f32_16x16x32_bf16 v[172:175], v[52:55], v[196:199], v[172:175]
    v_mfma_f32_16x16x32_bf16 v[176:179], v[56:59], v[196:199], v[176:179]
    v_mfma_f32_16x16x32_bf16 v[220:223], v[60:63], v[196:199], v[220:223]
    s_waitcnt vmcnt(15)
    v_mfma_f32_16x16x32_bf16 v[224:227], v[44:47], v[200:203], v[224:227]
    v_mfma_f32_16x16x32_bf16 v[228:231], v[48:51], v[200:203], v[228:231]
    v_mfma_f32_16x16x32_bf16 v[232:235], v[52:55], v[200:203], v[232:235]
    v_mfma_f32_16x16x32_bf16 v[144:147], v[56:59], v[200:203], v[144:147]
    v_mfma_f32_16x16x32_bf16 v[148:151], v[60:63], v[200:203], v[148:151]
    s_add_u32 s90, s90, 64
    s_load_dwordx8 s[32:39], s[8:9], s90 glc
    s_waitcnt vmcnt(13)
    v_mfma_f32_16x16x32_bf16 v[164:167], v[64:67], v[204:207], v[164:167]
    v_mfma_f32_16x16x32_bf16 v[168:171], v[68:71], v[204:207], v[168:171]
    v_mfma_f32_16x16x32_bf16 v[172:175], v[72:75], v[204:207], v[172:175]
    v_mfma_f32_16x16x32_bf16 v[176:179], v[76:79], v[204:207], v[176:179]
    v_mfma_f32_16x16x32_bf16 v[220:223], v[80:83], v[204:207], v[220:223]
    s_waitcnt vmcnt(12)
    v_mfma_f32_16x16x32_bf16 v[224:227], v[64:67], v[208:211], v[224:227]
    v_mfma_f32_16x16x32_bf16 v[228:231], v[68:71], v[208:211], v[228:231]
    v_mfma_f32_16x16x32_bf16 v[232:235], v[72:75], v[208:211], v[232:235]
    v_mfma_f32_16x16x32_bf16 v[144:147], v[76:79], v[208:211], v[144:147]
    v_mfma_f32_16x16x32_bf16 v[148:151], v[80:83], v[208:211], v[148:151]
    s_mov_b32 s41, 0x8000
K2_PSa1:
    s_waitcnt lgkmcnt(0)
    s_and_b64 s[32:33], s[32:33], s[38:39]
    s_and_b64 s[34:35], s[34:35], s[36:37]
    s_and_b64 s[32:33], s[32:33], s[34:35]
    s_and_b32 s33, s33, s32
    s_cbranch_scc1 K2_PDa1
    s_load_dwordx8 s[32:39], s[8:9], s90 glc
    s_sub_u32 s41, s41, 1
    s_cbranch_scc0 K2_PSa1
    s_waitcnt lgkmcnt(0)
K2_PDa1:
    s_lshl_b32 s56, s93, 11
    s_add_u32 s56, s56, s101
    s_add_u32 s56, s56, 110592
    buffer_load_dwordx4 v[196:199], v1, s[8:11], s56 offen offset:0 sc1
    buffer_load_dwordx4 v[200:203], v1, s[8:11], s56 offen offset:1024 sc1
    s_lshl_b32 s56, s94, 11
    s_add_u32 s56, s56, s101
    s_add_u32 s56, s56, 110592
    buffer_load_dwordx4 v[204:207], v1, s[8:11], s56 offen offset:0 sc1
    buffer_load_dwordx4 v[208:211], v1, s[8:11], s56 offen offset:1024 sc1
    s_waitcnt vmcnt(9)
    v_mfma_f32_16x16x32_bf16 v[164:167], v[84:87], v[152:155], v[164:167]
    v_mfma_f32_16x16x32_bf16 v[168:171], v[88:91], v[152:155], v[168:171]
    v_mfma_f32_16x16x32_bf16 v[172:175], v[92:95], v[152:155], v[172:175]
    v_mfma_f32_16x16x32_bf16 v[176:179], v[96:99], v[152:155], v[176:179]
    v_mfma_f32_16x16x32_bf16 v[220:223], v[100:103], v[152:155], v[220:223]
    s_waitcnt vmcnt(8)
    v_mfma_f32_16x16x32_bf16 v[224:227], v[84:87], v[156:159], v[224:227]
    v_mfma_f32_16x16x32_bf16 v[228:231], v[88:91], v[156:159], v[228:231]
    v_mfma_f32_16x16x32_bf16 v[232:235], v[92:95], v[156:159], v[232:235]
    v_mfma_f32_16x16x32_bf16 v[144:147], v[96:99], v[156:159], v[144:147]
    v_mfma_f32_16x16x32_bf16 v[148:151], v[100:103], v[156:159], v[148:151]
    s_lshl_b32 s56, s95, 11
    s_add_u32 s56, s56, s101
    s_add_u32 s56, s56, 110592
    buffer_load_dwordx4 v[152:155], v1, s[8:11], s56 offen offset:0 sc1
    buffer_load_dwordx4 v[156:159], v1, s[8:11], s56 offen offset:1024 sc1
    s_waitcnt vmcnt(9)
    v_mfma_f32_16x16x32_bf16 v[164:167], v[104:107], v[212:215], v[164:167]
    v_mfma_f32_16x16x32_bf16 v[168:171], v[108:111], v[212:215], v[168:171]
    v_mfma_f32_16x16x32_bf16 v[172:175], v[112:115], v[212:215], v[172:175]
    v_mfma_f32_16x16x32_bf16 v[176:179], v[116:119], v[212:215], v[176:179]
    v_mfma_f32_16x16x32_bf16 v[220:223], v[120:123], v[212:215], v[220:223]
    s_waitcnt vmcnt(8)
    v_mfma_f32_16x16x32_bf16 v[224:227], v[104:107], v[216:219], v[224:227]
    v_mfma_f32_16x16x32_bf16 v[228:231], v[108:111], v[216:219], v[228:231]
    v_mfma_f32_16x16x32_bf16 v[232:235], v[112:115], v[216:219], v[232:235]
    v_mfma_f32_16x16x32_bf16 v[144:147], v[116:119], v[216:219], v[144:147]
    v_mfma_f32_16x16x32_bf16 v[148:151], v[120:123], v[216:219], v[148:151]
    s_lshl_b32 s56, s96, 11
    s_add_u32 s56, s56, s101
    s_add_u32 s56, s56, 110592
    buffer_load_dwordx4 v[212:215], v1, s[8:11], s56 offen offset:0 sc1
    buffer_load_dwordx4 v[216:219], v1, s[8:11], s56 offen offset:1024 sc1
    s_waitcnt vmcnt(9)
    v_mfma_f32_16x16x32_bf16 v[164:167], v[124:127], v[188:191], v[164:167]
    v_mfma_f32_16x16x32_bf16 v[168:171], v[128:131], v[188:191], v[168:171]
    v_mfma_f32_16x16x32_bf16 v[172:175], v[132:135], v[188:191], v[172:175]
    v_mfma_f32_16x16x32_bf16 v[176:179], v[136:139], v[188:191], v[176:179]
    v_mfma_f32_16x16x32_bf16 v[220:223], v[140:143], v[188:191], v[220:223]
    s_waitcnt vmcnt(8)
    v_mfma_f32_16x16x32_bf16 v[224:227], v[124:127], v[192:195], v[224:227]
    v_mfma_f32_16x16x32_bf16 v[228:231], v[128:131], v[192:195], v[228:231]
    v_mfma_f32_16x16x32_bf16 v[232:235], v[132:135], v[192:195], v[232:235]
    v_mfma_f32_16x16x32_bf16 v[144:147], v[136:139], v[192:195], v[144:147]
    v_mfma_f32_16x16x32_bf16 v[148:151], v[140:143], v[192:195], v[148:151]
    s_lshl_b32 s56, s97, 11
    s_add_u32 s56, s56, s101
    s_add_u32 s56, s56, 110592
    buffer_load_dwordx4 v[188:191], v1, s[8:11], s56 offen offset:0 sc1
    buffer_load_dwordx4 v[192:195], v1, s[8:11], s56 offen offset:1024 sc1
    s_setprio 0
    v_mov_b32 v253, 160256
K2_CWa:
    ds_read_b32 v254, v253 offset:0
    s_waitcnt lgkmcnt(0)
    v_cmp_ne_u32 vcc, 8, v254
    s_cbranch_vccnz K2_CWa
    ds_write_b128 v244, v[164:167] offset:0
    ds_write_b128 v245, v[168:171] offset:1024
    ds_write_b128 v246, v[172:175] offset:2048
    ds_write_b128 v247, v[176:179] offset:3072
    ds_write_b128 v248, v[220:223] offset:4096
    ds_write_b128 v244, v[224:227] offset:5120
    ds_write_b128 v245, v[228:231] offset:6144
    ds_write_b128 v246, v[232:235] offset:7168
    ds_write_b128 v247, v[144:147] offset:8192
    ds_write_b128 v248, v[148:151] offset:9216
    s_cmp_lt_u32 s16, 4
    s_cselect_b32 s41, -1, 1
    s_mul_i32 s41, s41, 40960
    v_mfma_f32_16x16x32_bf16 v[164:167], v[4:7], v[180:183], 0
    v_mfma_f32_16x16x32_bf16 v[168:171], v[8:11], v[180:183], 0
    v_mfma_f32_16x16x32_bf16 v[172:175], v[12:15], v[180:183], 0
    v_mfma_f32_16x16x32_bf16 v[176:179], v[16:19], v[180:183], 0
    v_mfma_f32_16x16x32_bf16 v[220:223], v[20:23], v[180:183], 0
    v_mfma_f32_16x16x32_bf16 v[224:227], v[4:7], v[184:187], 0
    v_mfma_f32_16x16x32_bf16 v[228:231], v[8:11], v[184:187], 0
    v_mfma_f32_16x16x32_bf16 v[232:235], v[12:15], v[184:187], 0
    v_mfma_f32_16x16x32_bf16 v[144:147], v[16:19], v[184:187], 0
    v_mfma_f32_16x16x32_bf16 v[148:151], v[20:23], v[184:187], 0
    s_lshl_b32 s56, s98, 11
    s_add_u32 s56, s56, s101
    s_add_u32 s56, s56, 110592
    buffer_load_dwordx4 v[180:183], v1, s[8:11], s56 offen offset:0 sc1
    buffer_load_dwordx4 v[184:187], v1, s[8:11], s56 offen offset:1024 sc1
    s_waitcnt lgkmcnt(0)
    v_add_u32 v244, s41, v244
    v_add_u32 v245, s41, v245
    v_add_u32 v246, s41, v246
    v_add_u32 v247, s41, v247
    v_add_u32 v248, s41, v248
    s_waitcnt vmcnt(11)
    v_mfma_f32_16x16x32_bf16 v[164:167], v[24:27], v[196:199], v[164:167]
    v_mfma_f32_16x16x32_bf16 v[168:171], v[28:31], v[196:199], v[168:171]
    v_mfma_f32_16x16x32_bf16 v[172:175], v[32:35], v[196:199], v[172:175]
    v_mfma_f32_16x16x32_bf16 v[176:179], v[36:39], v[196:199], v[176:179]
    v_mfma_f32_16x16x32_bf16 v[220:223], v[40:43], v[196:199], v[220:223]
    s_waitcnt vmcnt(10)
    v_mfma_f32_16x16x32_bf16 v[224:227], v[24:27], v[200:203], v[224:227]
    v_mfma_f32_16x16x32_bf16 v[228:231], v[28:31], v[200:203], v[228:231]
    v_mfma_f32_16x16x32_bf16 v[232:235], v[32:35], v[200:203], v[232:235]
    v_mfma_f32_16x16x32_bf16 v[144:147], v[36:39], v[200:203], v[144:147]
    v_mfma_f32_16x16x32_bf16 v[148:151], v[40:43], v[200:203], v[148:151]
    s_cmp_lt_u32 s16, 4
    s_cbranch_scc1 K2_BM1
    s_barrier
K2_BM1:
    s_waitcnt vmcnt(9)
    v_mfma_f32_16x16x32_bf16 v[164:167], v[44:47], v[204:207], v[164:167]
    v_mfma_f32_16x16x32_bf16 v[168:171], v[48:51], v[204:207], v[168:171]
    v_mfma_f32_16x16x32_bf16 v[172:175], v[52:55], v[204:207], v[172:175]
    v_mfma_f32_16x16x32_bf16 v[176:179], v[56:59], v[204:207], v[176:179]
    v_mfma_f32_16x16x32_bf16 v[220:223], v[60:63], v[204:207], v[220:223]
    s_waitcnt vmcnt(8)
    v_mfma_f32_16x16x32_bf16 v[224:227], v[44:47], v[208:211], v[224:227]
    v_mfma_f32_16x16x32_bf16 v[228:231], v[48:51], v[208:211], v[228:231]
    v_mfma_f32_16x16x32_bf16 v[232:235], v[52:55], v[208:211], v[232:235]
    v_mfma_f32_16x16x32_bf16 v[144:147], v[56:59], v[208:211], v[144:147]
    v_mfma_f32_16x16x32_bf16 v[148:151], v[60:63], v[208:211], v[148:151]
    s_waitcnt vmcnt(7)
    v_mfma_f32_16x16x32_bf16 v[164:167], v[64:67], v[152:155], v[164:167]
    v_mfma_f32_16x16x32_bf16 v[168:171], v[68:71], v[152:155], v[168:171]
    v_mfma_f32_16x16x32_bf16 v[172:175], v[72:75], v[152:155], v[172:175]
    v_mfma_f32_16x16x32_bf16 v[176:179], v[76:79], v[152:155], v[176:179]
    v_mfma_f32_16x16x32_bf16 v[220:223], v[80:83], v[152:155], v[220:223]
    s_waitcnt vmcnt(6)
    v_mfma_f32_16x16x32_bf16 v[224:227], v[64:67], v[156:159], v[224:227]
    v_mfma_f32_16x16x32_bf16 v[228:231], v[68:71], v[156:159], v[228:231]
    v_mfma_f32_16x16x32_bf16 v[232:235], v[72:75], v[156:159], v[232:235]
    v_mfma_f32_16x16x32_bf16 v[144:147], v[76:79], v[156:159], v[144:147]
    v_mfma_f32_16x16x32_bf16 v[148:151], v[80:83], v[156:159], v[148:151]
    s_waitcnt vmcnt(5)
    v_mfma_f32_16x16x32_bf16 v[164:167], v[84:87], v[212:215], v[164:167]
    v_mfma_f32_16x16x32_bf16 v[168:171], v[88:91], v[212:215], v[168:171]
    v_mfma_f32_16x16x32_bf16 v[172:175], v[92:95], v[212:215], v[172:175]
    v_mfma_f32_16x16x32_bf16 v[176:179], v[96:99], v[212:215], v[176:179]
    v_mfma_f32_16x16x32_bf16 v[220:223], v[100:103], v[212:215], v[220:223]
    s_waitcnt vmcnt(4)
    v_mfma_f32_16x16x32_bf16 v[224:227], v[84:87], v[216:219], v[224:227]
    v_mfma_f32_16x16x32_bf16 v[228:231], v[88:91], v[216:219], v[228:231]
    v_mfma_f32_16x16x32_bf16 v[232:235], v[92:95], v[216:219], v[232:235]
    v_mfma_f32_16x16x32_bf16 v[144:147], v[96:99], v[216:219], v[144:147]
    v_mfma_f32_16x16x32_bf16 v[148:151], v[100:103], v[216:219], v[148:151]
    s_cmp_ge_u32 s16, 4
    s_cbranch_scc1 K2_BM2
    s_barrier
K2_BM2:
    s_waitcnt vmcnt(3)
    v_mfma_f32_16x16x32_bf16 v[164:167], v[104:107], v[188:191], v[164:167]
    s_waitcnt vmcnt(1)
    v_mfma_f32_16x16x32_bf16 v[164:167], v[124:127], v[180:183], v[164:167]
    v_mfma_f32_16x16x32_bf16 v[168:171], v[108:111], v[188:191], v[168:171]
    v_mfma_f32_16x16x32_bf16 v[168:171], v[128:131], v[180:183], v[168:171]
    v_mfma_f32_16x16x32_bf16 v[172:175], v[112:115], v[188:191], v[172:175]
    v_mfma_f32_16x16x32_bf16 v[172:175], v[132:135], v[180:183], v[172:175]
    v_mfma_f32_16x16x32_bf16 v[176:179], v[116:119], v[188:191], v[176:179]
    v_mfma_f32_16x16x32_bf16 v[176:179], v[136:139], v[180:183], v[176:179]
    s_nop 1
    ds_write_b128 v244, v[164:167] offset:0
    v_mfma_f32_16x16x32_bf16 v[220:223], v[120:123], v[188:191], v[220:223]
    v_mfma_f32_16x16x32_bf16 v[220:223], v[140:143], v[180:183], v[220:223]
    ds_write_b128 v245, v[168:171] offset:1024
    v_mfma_f32_16x16x32_bf16 v[224:227], v[104:107], v[192:195], v[224:227]
    s_waitcnt vmcnt(0)
    v_mfma_f32_16x16x32_bf16 v[224:227], v[124:127], v[184:187], v[224:227]
    ds_write_b128 v246, v[172:175] offset:2048
    v_mfma_f32_16x16x32_bf16 v[228:231], v[108:111], v[192:195], v[228:231]
    v_mfma_f32_16x16x32_bf16 v[228:231], v[128:131], v[184:187], v[228:231]
    ds_write_b128 v247, v[176:179] offset:3072
    v_mfma_f32_16x16x32_bf16 v[232:235], v[112:115], v[192:195], v[232:235]
    v_mfma_f32_16x16x32_bf16 v[232:235], v[132:135], v[184:187], v[232:235]
    ds_write_b128 v248, v[220:223] offset:4096
    v_mfma_f32_16x16x32_bf16 v[144:147], v[116:119], v[192:195], v[144:147]
    v_mfma_f32_16x16x32_bf16 v[144:147], v[136:139], v[184:187], v[144:147]
    ds_write_b128 v244, v[224:227] offset:5120
    v_mfma_f32_16x16x32_bf16 v[148:151], v[120:123], v[192:195], v[148:151]
    v_mfma_f32_16x16x32_bf16 v[148:151], v[140:143], v[184:187], v[148:151]
    ds_write_b128 v245, v[228:231] offset:6144
    s_nop 0
    ds_write_b128 v246, v[232:235] offset:7168
    s_nop 1
    ds_write_b128 v247, v[144:147] offset:8192
    s_nop 1
    ds_write_b128 v248, v[148:151] offset:9216
    s_cmp_ge_u32 s16, 4
    s_cbranch_scc1 K2_BF
    v_add_u32 v253, 40960, v241
    v_add_u32 v254, 81920, v241
    s_mul_i32 s40, s20, 160
    v_xor_b32 v236, 16, v253
    v_xor_b32 v237, 16, v254
    ds_read_b128 v[4:7], v253 offset:0
    ds_read_b128 v[8:11], v236 offset:0
    ds_read_b128 v[12:15], v253 offset:10240
    ds_read_b128 v[16:19], v236 offset:10240
    ds_read_b128 v[20:23], v253 offset:20480
    ds_read_b128 v[24:27], v236 offset:20480
    ds_read_b128 v[28:31], v253 offset:30720
    ds_read_b128 v[32:35], v236 offset:30720
    ds_read_b128 v[36:39], v254 offset:0
    ds_read_b128 v[40:43], v237 offset:0
    ds_read_b128 v[44:47], v254 offset:10240
    ds_read_b128 v[48:51], v237 offset:10240
    ds_read_b128 v[52:55], v254 offset:20480
    ds_read_b128 v[56:59], v237 offset:20480
    ds_read_b128 v[60:63], v254 offset:30720
    ds_read_b128 v[64:67], v237 offset:30720
    s_waitcnt lgkmcnt(13)
    v_pk_add_f32 v[4:5], v[4:5], v[12:13]
    v_pk_add_f32 v[6:7], v[6:7], v[14:15]
    s_waitcnt lgkmcnt(12)
    v_pk_add_f32 v[8:9], v[8:9], v[16:17]
    v_pk_add_f32 v[10:11], v[10:11], v[18:19]
    s_waitcnt lgkmcnt(11)
    v_pk_add_f32 v[4:5], v[4:5], v[20:21]
    v_pk_add_f32 v[6:7], v[6:7], v[22:23]
    s_waitcnt lgkmcnt(10)
    v_pk_add_f32 v[8:9], v[8:9], v[24:25]
    v_pk_add_f32 v[10:11], v[10:11], v[26:27]
    s_waitcnt lgkmcnt(9)
    v_pk_add_f32 v[4:5], v[4:5], v[28:29]
    v_pk_add_f32 v[6:7], v[6:7], v[30:31]
    s_waitcnt lgkmcnt(8)
    v_pk_add_f32 v[8:9], v[8:9], v[32:33]
    v_pk_add_f32 v[10:11], v[10:11], v[34:35]
    s_waitcnt lgkmcnt(7)
    v_pk_add_f32 v[4:5], v[4:5], v[36:37]
    v_pk_add_f32 v[6:7], v[6:7], v[38:39]
    s_waitcnt lgkmcnt(6)
    v_pk_add_f32 v[8:9], v[8:9], v[40:41]
    v_pk_add_f32 v[10:11], v[10:11], v[42:43]
    s_waitcnt lgkmcnt(5)
    v_pk_add_f32 v[4:5], v[4:5], v[44:45]
    v_pk_add_f32 v[6:7], v[6:7], v[46:47]
    s_waitcnt lgkmcnt(4)
    v_pk_add_f32 v[8:9], v[8:9], v[48:49]
    v_pk_add_f32 v[10:11], v[10:11], v[50:51]
    s_waitcnt lgkmcnt(3)
    v_pk_add_f32 v[4:5], v[4:5], v[52:53]
    v_pk_add_f32 v[6:7], v[6:7], v[54:55]
    s_waitcnt lgkmcnt(2)
    v_pk_add_f32 v[8:9], v[8:9], v[56:57]
    v_pk_add_f32 v[10:11], v[10:11], v[58:59]
    s_waitcnt lgkmcnt(1)
    v_pk_add_f32 v[4:5], v[4:5], v[60:61]
    v_pk_add_f32 v[6:7], v[6:7], v[62:63]
    s_waitcnt lgkmcnt(0)
    v_pk_add_f32 v[8:9], v[8:9], v[64:65]
    v_pk_add_f32 v[10:11], v[10:11], v[66:67]
    v_cvt_pk_bf16_f32 v68, v4, v5
    v_cvt_pk_bf16_f32 v69, v6, v7
    v_cvt_pk_bf16_f32 v70, v8, v9
    v_cvt_pk_bf16_f32 v71, v10, v11
    buffer_store_dwordx4 v[68:71], v242, s[52:55], s40 offen
K2_BF:
    s_cmp_ge_u32 s16, 5
    s_cselect_b32 s40, 40960, 0
    s_cselect_b64 s[42:43], -1, 0
    s_mov_b32 s41, 122880
    s_cselect_b32 s41, 81920, s41
    v_add_u32 v253, s40, v241
    v_add_u32 v254, s41, v241
    v_cndmask_b32 v255, v243, v242, s[42:43]
    s_waitcnt lgkmcnt(0)
    s_barrier
    s_cmp_ge_u32 s16, 7
    s_cbranch_scc1 K2_DONE
    s_mul_i32 s40, s20, 160
    v_xor_b32 v236, 16, v253
    v_xor_b32 v237, 16, v254
    ds_read_b128 v[4:7], v253 offset:0
    ds_read_b128 v[8:11], v236 offset:0
    ds_read_b128 v[12:15], v253 offset:10240
    ds_read_b128 v[16:19], v236 offset:10240
    ds_read_b128 v[20:23], v253 offset:20480
    ds_read_b128 v[24:27], v236 offset:20480
    ds_read_b128 v[28:31], v253 offset:30720
    ds_read_b128 v[32:35], v236 offset:30720
    ds_read_b128 v[36:39], v254 offset:0
    ds_read_b128 v[40:43], v237 offset:0
    ds_read_b128 v[44:47], v254 offset:10240
    ds_read_b128 v[48:51], v237 offset:10240
    ds_read_b128 v[52:55], v254 offset:20480
    ds_read_b128 v[56:59], v237 offset:20480
    ds_read_b128 v[60:63], v254 offset:30720
    ds_read_b128 v[64:67], v237 offset:30720
    s_waitcnt lgkmcnt(13)
    v_pk_add_f32 v[4:5], v[4:5], v[12:13]
    v_pk_add_f32 v[6:7], v[6:7], v[14:15]
    s_waitcnt lgkmcnt(12)
    v_pk_add_f32 v[8:9], v[8:9], v[16:17]
    v_pk_add_f32 v[10:11], v[10:11], v[18:19]
    s_waitcnt lgkmcnt(11)
    v_pk_add_f32 v[4:5], v[4:5], v[20:21]
    v_pk_add_f32 v[6:7], v[6:7], v[22:23]
    s_waitcnt lgkmcnt(10)
    v_pk_add_f32 v[8:9], v[8:9], v[24:25]
    v_pk_add_f32 v[10:11], v[10:11], v[26:27]
    s_waitcnt lgkmcnt(9)
    v_pk_add_f32 v[4:5], v[4:5], v[28:29]
    v_pk_add_f32 v[6:7], v[6:7], v[30:31]
    s_waitcnt lgkmcnt(8)
    v_pk_add_f32 v[8:9], v[8:9], v[32:33]
    v_pk_add_f32 v[10:11], v[10:11], v[34:35]
    s_waitcnt lgkmcnt(7)
    v_pk_add_f32 v[4:5], v[4:5], v[36:37]
    v_pk_add_f32 v[6:7], v[6:7], v[38:39]
    s_waitcnt lgkmcnt(6)
    v_pk_add_f32 v[8:9], v[8:9], v[40:41]
    v_pk_add_f32 v[10:11], v[10:11], v[42:43]
    s_waitcnt lgkmcnt(5)
    v_pk_add_f32 v[4:5], v[4:5], v[44:45]
    v_pk_add_f32 v[6:7], v[6:7], v[46:47]
    s_waitcnt lgkmcnt(4)
    v_pk_add_f32 v[8:9], v[8:9], v[48:49]
    v_pk_add_f32 v[10:11], v[10:11], v[50:51]
    s_waitcnt lgkmcnt(3)
    v_pk_add_f32 v[4:5], v[4:5], v[52:53]
    v_pk_add_f32 v[6:7], v[6:7], v[54:55]
    s_waitcnt lgkmcnt(2)
    v_pk_add_f32 v[8:9], v[8:9], v[56:57]
    v_pk_add_f32 v[10:11], v[10:11], v[58:59]
    s_waitcnt lgkmcnt(1)
    v_pk_add_f32 v[4:5], v[4:5], v[60:61]
    v_pk_add_f32 v[6:7], v[6:7], v[62:63]
    s_waitcnt lgkmcnt(0)
    v_pk_add_f32 v[8:9], v[8:9], v[64:65]
    v_pk_add_f32 v[10:11], v[10:11], v[66:67]
    v_cvt_pk_bf16_f32 v68, v4, v5
    v_cvt_pk_bf16_f32 v69, v6, v7
    v_cvt_pk_bf16_f32 v70, v8, v9
    v_cvt_pk_bf16_f32 v71, v10, v11
    buffer_store_dwordx4 v[68:71], v255, s[52:55], s40 offen
K2_DONE:
    s_endpgm
K2_W0:
    s_setprio 3
    v_mov_b32 v253, 160256
    v_mov_b32 v254, 0
    ds_write_b32 v253, v254 offset:0
    ds_write_b32 v253, v254 offset:4
    ds_write_b32 v253, v254 offset:8
    ds_write_b32 v253, v254 offset:12
    v_mov_b32 v212, 0x3f803f80
    v_mov_b32 v213, 0x3f803f80
    v_mov_b32 v214, 0x3f803f80
    v_mov_b32 v215, 0x3f803f80
    v_and_b32 v253, 3, v251
    v_cmp_eq_u32 s[28:29], 1, v253
    v_cmp_eq_u32 s[30:31], 2, v253
    v_cmp_eq_u32 s[32:33], 3, v253
    v_lshrrev_b32 v253, 2, v251
    v_cmp_eq_u32 s[34:35], v253, v252
    ds_read_b128 v[180:183], v3 offset:0
    ds_read_b128 v[184:187], v3 offset:20480
    ds_read_b128 v[188:191], v3 offset:1024
    ds_read_b128 v[192:195], v3 offset:21504
    ds_read_b128 v[196:199], v3 offset:2048
    ds_read_b128 v[200:203], v3 offset:22528
    ds_read_b128 v[204:207], v3 offset:3072
    s_waitcnt lgkmcnt(6)
    v_mfma_f32_16x16x32_bf16 v[164:167], v[212:215], v[180:183], 0
    v_mfma_f32_16x16x32_bf16 v[172:175], v[180:183], v[180:183], 0
    ds_read_b128 v[208:211], v3 offset:23552
    s_waitcnt lgkmcnt(6)
    v_mfma_f32_16x16x32_bf16 v[168:171], v[212:215], v[184:187], 0
    v_mfma_f32_16x16x32_bf16 v[176:179], v[184:187], v[184:187], 0
    ds_read_b128 v[180:183], v3 offset:4096
    s_barrier
    s_waitcnt lgkmcnt(6)
    v_mfma_f32_16x16x32_bf16 v[164:167], v[212:215], v[188:191], v[164:167]
    v_mfma_f32_16x16x32_bf16 v[172:175], v[188:191], v[188:191], v[172:175]
    ds_read_b128 v[184:187], v3 offset:24576
    s_waitcnt lgkmcnt(6)
    v_mfma_f32_16x16x32_bf16 v[168:171], v[212:215], v[192:195], v[168:171]
    v_mfma_f32_16x16x32_bf16 v[176:179], v[192:195], v[192:195], v[176:179]
    ds_read_b128 v[188:191], v3 offset:5120
    s_waitcnt lgkmcnt(6)
    v_mfma_f32_16x16x32_bf16 v[164:167], v[212:215], v[196:199], v[164:167]
    v_mfma_f32_16x16x32_bf16 v[172:175], v[196:199], v[196:199], v[172:175]
    ds_read_b128 v[192:195], v3 offset:25600
    s_waitcnt lgkmcnt(6)
    v_mfma_f32_16x16x32_bf16 v[168:171], v[212:215], v[200:203], v[168:171]
    v_mfma_f32_16x16x32_bf16 v[176:179], v[200:203], v[200:203], v[176:179]
    ds_read_b128 v[196:199], v3 offset:6144
    s_waitcnt lgkmcnt(6)
    v_mfma_f32_16x16x32_bf16 v[164:167], v[212:215], v[204:207], v[164:167]
    v_mfma_f32_16x16x32_bf16 v[172:175], v[204:207], v[204:207], v[172:175]
    ds_read_b128 v[200:203], v3 offset:26624
    s_waitcnt lgkmcnt(6)
    v_mfma_f32_16x16x32_bf16 v[168:171], v[212:215], v[208:211], v[168:171]
    v_mfma_f32_16x16x32_bf16 v[176:179], v[208:211], v[208:211], v[176:179]
    ds_read_b128 v[204:207], v3 offset:7168
    s_waitcnt lgkmcnt(6)
    v_mfma_f32_16x16x32_bf16 v[164:167], v[212:215], v[180:183], v[164:167]
    v_mfma_f32_16x16x32_bf16 v[172:175], v[180:183], v[180:183], v[172:175]
    ds_read_b128 v[208:211], v3 offset:27648
    s_waitcnt lgkmcnt(6)
    v_mfma_f32_16x16x32_bf16 v[168:171], v[212:215], v[184:187], v[168:171]
    v_mfma_f32_16x16x32_bf16 v[176:179], v[184:187], v[184:187], v[176:179]
    ds_read_b128 v[180:183], v3 offset:8192
    s_waitcnt lgkmcnt(6)
    v_mfma_f32_16x16x32_bf16 v[164:167], v[212:215], v[188:191], v[164:167]
    v_mfma_f32_16x16x32_bf16 v[172:175], v[188:191], v[188:191], v[172:175]
    ds_read_b128 v[184:187], v3 offset:28672
    s_waitcnt lgkmcnt(6)
    v_mfma_f32_16x16x32_bf16 v[168:171], v[212:215], v[192:195], v[168:171]
    v_mfma_f32_16x16x32_bf16 v[176:179], v[192:195], v[192:195], v[176:179]
    ds_read_b128 v[188:191], v3 offset:9216
    s_waitcnt lgkmcnt(6)
    v_mfma_f32_16x16x32_bf16 v[164:167], v[212:215], v[196:199], v[164:167]
    v_mfma_f32_16x16x32_bf16 v[172:175], v[196:199], v[196:199], v[172:175]
    ds_read_b128 v[192:195], v3 offset:29696
    s_waitcnt lgkmcnt(6)
    v_mfma_f32_16x16x32_bf16 v[168:171], v[212:215], v[200:203], v[168:171]
    v_mfma_f32_16x16x32_bf16 v[176:179], v[200:203], v[200:203], v[176:179]
    ds_read_b128 v[196:199], v3 offset:10240
    s_waitcnt lgkmcnt(6)
    v_mfma_f32_16x16x32_bf16 v[164:167], v[212:215], v[204:207], v[164:167]
    v_mfma_f32_16x16x32_bf16 v[172:175], v[204:207], v[204:207], v[172:175]
    ds_read_b128 v[200:203], v3 offset:30720
    s_waitcnt lgkmcnt(6)
    v_mfma_f32_16x16x32_bf16 v[168:171], v[212:215], v[208:211], v[168:171]
    v_mfma_f32_16x16x32_bf16 v[176:179], v[208:211], v[208:211], v[176:179]
    ds_read_b128 v[204:207], v3 offset:11264
    s_waitcnt lgkmcnt(6)
    v_mfma_f32_16x16x32_bf16 v[164:167], v[212:215], v[180:183], v[164:167]
    v_mfma_f32_16x16x32_bf16 v[172:175], v[180:183], v[180:183], v[172:175]
    ds_read_b128 v[208:211], v3 offset:31744
    s_waitcnt lgkmcnt(6)
    v_mfma_f32_16x16x32_bf16 v[168:171], v[212:215], v[184:187], v[168:171]
    v_mfma_f32_16x16x32_bf16 v[176:179], v[184:187], v[184:187], v[176:179]
    ds_read_b128 v[180:183], v3 offset:12288
    s_waitcnt lgkmcnt(6)
    v_mfma_f32_16x16x32_bf16 v[164:167], v[212:215], v[188:191], v[164:167]
    v_mfma_f32_16x16x32_bf16 v[172:175], v[188:191], v[188:191], v[172:175]
    ds_read_b128 v[184:187], v3 offset:32768
    s_waitcnt lgkmcnt(6)
    v_mfma_f32_16x16x32_bf16 v[168:171], v[212:215], v[192:195], v[168:171]
    v_mfma_f32_16x16x32_bf16 v[176:179], v[192:195], v[192:195], v[176:179]
    ds_read_b128 v[188:191], v3 offset:13312
    s_waitcnt lgkmcnt(6)
    v_mfma_f32_16x16x32_bf16 v[164:167], v[212:215], v[196:199], v[164:167]
    v_mfma_f32_16x16x32_bf16 v[172:175], v[196:199], v[196:199], v[172:175]
    ds_read_b128 v[192:195], v3 offset:33792
    s_waitcnt lgkmcnt(6)
    v_mfma_f32_16x16x32_bf16 v[168:171], v[212:215], v[200:203], v[168:171]
    v_mfma_f32_16x16x32_bf16 v[176:179], v[200:203], v[200:203], v[176:179]
    ds_read_b128 v[196:199], v3 offset:14336
    s_waitcnt lgkmcnt(6)
    v_mfma_f32_16x16x32_bf16 v[164:167], v[212:215], v[204:207], v[164:167]
    v_mfma_f32_16x16x32_bf16 v[172:175], v[204:207], v[204:207], v[172:175]
    ds_read_b128 v[200:203], v3 offset:34816
    s_waitcnt lgkmcnt(6)
    v_mfma_f32_16x16x32_bf16 v[168:171], v[212:215], v[208:211], v[168:171]
    v_mfma_f32_16x16x32_bf16 v[176:179], v[208:211], v[208:211], v[176:179]
    ds_read_b128 v[204:207], v3 offset:15360
    s_waitcnt lgkmcnt(6)
    v_mfma_f32_16x16x32_bf16 v[164:167], v[212:215], v[180:183], v[164:167]
    v_mfma_f32_16x16x32_bf16 v[172:175], v[180:183], v[180:183], v[172:175]
    ds_read_b128 v[208:211], v3 offset:35840
    s_waitcnt lgkmcnt(6)
    v_mfma_f32_16x16x32_bf16 v[168:171], v[212:215], v[184:187], v[168:171]
    v_mfma_f32_16x16x32_bf16 v[176:179], v[184:187], v[184:187], v[176:179]
    ds_read_b128 v[180:183], v3 offset:16384
    s_waitcnt lgkmcnt(6)
    v_mfma_f32_16x16x32_bf16 v[164:167], v[212:215], v[188:191], v[164:167]
    v_mfma_f32_16x16x32_bf16 v[172:175], v[188:191], v[188:191], v[172:175]
    ds_read_b128 v[184:187], v3 offset:36864
    s_waitcnt lgkmcnt(6)
    v_mfma_f32_16x16x32_bf16 v[168:171], v[212:215], v[192:195], v[168:171]
    v_mfma_f32_16x16x32_bf16 v[176:179], v[192:195], v[192:195], v[176:179]
    ds_read_b128 v[188:191], v3 offset:17408
    s_waitcnt lgkmcnt(6)
    v_mfma_f32_16x16x32_bf16 v[164:167], v[212:215], v[196:199], v[164:167]
    v_mfma_f32_16x16x32_bf16 v[172:175], v[196:199], v[196:199], v[172:175]
    ds_read_b128 v[192:195], v3 offset:37888
    s_waitcnt lgkmcnt(6)
    v_mfma_f32_16x16x32_bf16 v[168:171], v[212:215], v[200:203], v[168:171]
    v_mfma_f32_16x16x32_bf16 v[176:179], v[200:203], v[200:203], v[176:179]
    ds_read_b128 v[196:199], v3 offset:18432
    s_waitcnt lgkmcnt(6)
    v_mfma_f32_16x16x32_bf16 v[164:167], v[212:215], v[204:207], v[164:167]
    v_mfma_f32_16x16x32_bf16 v[172:175], v[204:207], v[204:207], v[172:175]
    ds_read_b128 v[200:203], v3 offset:38912
    s_waitcnt lgkmcnt(6)
    v_mfma_f32_16x16x32_bf16 v[168:171], v[212:215], v[208:211], v[168:171]
    v_mfma_f32_16x16x32_bf16 v[176:179], v[208:211], v[208:211], v[176:179]
    ds_read_b128 v[204:207], v3 offset:19456
    s_waitcnt lgkmcnt(6)
    v_mfma_f32_16x16x32_bf16 v[164:167], v[212:215], v[180:183], v[164:167]
    v_mfma_f32_16x16x32_bf16 v[172:175], v[180:183], v[180:183], v[172:175]
    ds_read_b128 v[208:211], v3 offset:39936
    s_waitcnt lgkmcnt(6)
    v_mfma_f32_16x16x32_bf16 v[168:171], v[212:215], v[184:187], v[168:171]
    v_mfma_f32_16x16x32_bf16 v[176:179], v[184:187], v[184:187], v[176:179]
    s_waitcnt lgkmcnt(5)
    v_mfma_f32_16x16x32_bf16 v[164:167], v[212:215], v[188:191], v[164:167]
    v_mfma_f32_16x16x32_bf16 v[172:175], v[188:191], v[188:191], v[172:175]
    s_waitcnt lgkmcnt(4)
    v_mfma_f32_16x16x32_bf16 v[168:171], v[212:215], v[192:195], v[168:171]
    v_mfma_f32_16x16x32_bf16 v[176:179], v[192:195], v[192:195], v[176:179]
    s_waitcnt lgkmcnt(3)
    v_mfma_f32_16x16x32_bf16 v[164:167], v[212:215], v[196:199], v[164:167]
    v_mfma_f32_16x16x32_bf16 v[172:175], v[196:199], v[196:199], v[172:175]
    s_waitcnt lgkmcnt(2)
    v_mfma_f32_16x16x32_bf16 v[168:171], v[212:215], v[200:203], v[168:171]
    v_mfma_f32_16x16x32_bf16 v[176:179], v[200:203], v[200:203], v[176:179]
    s_waitcnt lgkmcnt(1)
    v_mfma_f32_16x16x32_bf16 v[164:167], v[212:215], v[204:207], v[164:167]
    v_mfma_f32_16x16x32_bf16 v[172:175], v[204:207], v[204:207], v[172:175]
    s_waitcnt lgkmcnt(0)
    v_mfma_f32_16x16x32_bf16 v[168:171], v[212:215], v[208:211], v[168:171]
    v_mfma_f32_16x16x32_bf16 v[176:179], v[208:211], v[208:211], v[176:179]
    v_lshlrev_b32 v253, 3, v251
    v_add_u32 v253, 159744, v253
    s_nop 2
    v_cndmask_b32 v172, v172, v173, s[28:29]
    v_cndmask_b32 v172, v172, v174, s[30:31]
    v_cndmask_b32 v172, v172, v175, s[32:33]
    v_mul_f32 v236, 0xbacccccd, v164
    v_mul_f32 v172, 0x3acccccd, v172
    v_fma_f32 v172, -v236, v236, v172
    v_max_f32 v172, 0, v172
    v_add_f32 v172, 0x3727c5ac, v172
    v_rsq_f32 v237, v172
    v_cndmask_b32 v176, v176, v177, s[28:29]
    v_cndmask_b32 v176, v176, v178, s[30:31]
    v_cndmask_b32 v176, v176, v179, s[32:33]
    v_mul_f32 v238, 0xbacccccd, v168
    v_mul_f32 v176, 0x3acccccd, v176
    v_fma_f32 v176, -v238, v238, v176
    v_max_f32 v176, 0, v176
    v_add_f32 v176, 0x3727c5ac, v176
    v_rsq_f32 v239, v176
    s_mov_b64 exec, s[34:35]
    ds_write_b64 v253, v[236:237] offset:0
    ds_write_b64 v253, v[238:239] offset:128
    s_mov_b64 exec, -1
    v_mov_b32 v253, 160256
    v_mov_b32 v254, 1
    s_waitcnt lgkmcnt(0)
    ds_write_b32 v253, v254 offset:4
    s_setprio 0
    v_mov_b32 v253, 160256
K2_W2R0:
    ds_read_b32 v254, v253 offset:12
    s_waitcnt lgkmcnt(0)
    v_cmp_ne_u32 vcc, 4, v254
    s_cbranch_vccnz K2_W2R0
    v_add_u32 v2, 4096, v1
    s_mul_i32 s57, s93, 5120
    s_add_u32 s57, s57, s100
    s_waitcnt vmcnt(18)
    buffer_load_dwordx4 v[24:27], v1, s[8:11], s57 offen offset:0
    s_waitcnt vmcnt(18)
    buffer_load_dwordx4 v[28:31], v1, s[8:11], s57 offen offset:1024
    s_waitcnt vmcnt(18)
    buffer_load_dwordx4 v[32:35], v1, s[8:11], s57 offen offset:2048
    s_waitcnt vmcnt(18)
    buffer_load_dwordx4 v[36:39], v1, s[8:11], s57 offen offset:3072
    s_waitcnt vmcnt(18)
    buffer_load_dwordx4 v[40:43], v2, s[8:11], s57 offen offset:0
    s_mul_i32 s57, s94, 5120
    s_add_u32 s57, s57, s100
    s_waitcnt vmcnt(18)
    buffer_load_dwordx4 v[44:47], v1, s[8:11], s57 offen offset:0
    s_waitcnt vmcnt(18)
    buffer_load_dwordx4 v[48:51], v1, s[8:11], s57 offen offset:1024
    s_waitcnt vmcnt(18)
    buffer_load_dwordx4 v[52:55], v1, s[8:11], s57 offen offset:2048
    s_waitcnt vmcnt(18)
    buffer_load_dwordx4 v[56:59], v1, s[8:11], s57 offen offset:3072
    s_waitcnt vmcnt(18)
    buffer_load_dwordx4 v[60:63], v2, s[8:11], s57 offen offset:0
    s_mul_i32 s57, s95, 5120
    s_add_u32 s57, s57, s100
    s_waitcnt vmcnt(18)
    buffer_load_dwordx4 v[64:67], v1, s[8:11], s57 offen offset:0
    s_waitcnt vmcnt(18)
    buffer_load_dwordx4 v[68:71], v1, s[8:11], s57 offen offset:1024
    s_waitcnt vmcnt(18)
    buffer_load_dwordx4 v[72:75], v1, s[8:11], s57 offen offset:2048
    s_waitcnt vmcnt(18)
    buffer_load_dwordx4 v[76:79], v1, s[8:11], s57 offen offset:3072
    s_waitcnt vmcnt(18)
    buffer_load_dwordx4 v[80:83], v2, s[8:11], s57 offen offset:0
    s_mul_i32 s57, s96, 5120
    s_add_u32 s57, s57, s100
    s_waitcnt vmcnt(18)
    buffer_load_dwordx4 v[84:87], v1, s[8:11], s57 offen offset:0
    s_waitcnt vmcnt(18)
    buffer_load_dwordx4 v[88:91], v1, s[8:11], s57 offen offset:1024
    s_waitcnt vmcnt(18)
    buffer_load_dwordx4 v[92:95], v1, s[8:11], s57 offen offset:2048
    s_waitcnt vmcnt(18)
    buffer_load_dwordx4 v[96:99], v1, s[8:11], s57 offen offset:3072
    buffer_load_dwordx4 v[100:103], v2, s[8:11], s57 offen offset:0
    s_mul_i32 s57, s97, 5120
    s_add_u32 s57, s57, s100
    buffer_load_dwordx4 v[104:107], v1, s[8:11], s57 offen offset:0
    buffer_load_dwordx4 v[108:111], v1, s[8:11], s57 offen offset:1024
    buffer_load_dwordx4 v[112:115], v1, s[8:11], s57 offen offset:2048
    buffer_load_dwordx4 v[116:119], v1, s[8:11], s57 offen offset:3072
    buffer_load_dwordx4 v[120:123], v2, s[8:11], s57 offen offset:0
    s_mul_i32 s57, s98, 5120
    s_add_u32 s57, s57, s100
    buffer_load_dwordx4 v[124:127], v1, s[8:11], s57 offen offset:0
    buffer_load_dwordx4 v[128:131], v1, s[8:11], s57 offen offset:1024
    buffer_load_dwordx4 v[132:135], v1, s[8:11], s57 offen offset:2048
    buffer_load_dwordx4 v[136:139], v1, s[8:11], s57 offen offset:3072
    buffer_load_dwordx4 v[140:143], v2, s[8:11], s57 offen offset:0
    s_setprio 2
    ds_read_b128 v[180:183], v1 offset:0
    ds_read_b128 v[184:187], v1 offset:20480
    ds_read_b128 v[188:191], v1 offset:1024
    ds_read_b128 v[192:195], v1 offset:21504
    ds_read_b128 v[196:199], v1 offset:2048
    ds_read_b128 v[200:203], v1 offset:22528
    ds_read_b128 v[204:207], v1 offset:3072
    s_waitcnt lgkmcnt(6)
    v_mfma_f32_16x16x32_bf16 v[164:167], v[212:215], v[180:183], 0
    v_mfma_f32_16x16x32_bf16 v[172:175], v[180:183], v[180:183], 0
    ds_read_b128 v[208:211], v1 offset:23552
    s_waitcnt lgkmcnt(6)
    v_mfma_f32_16x16x32_bf16 v[168:171], v[212:215], v[184:187], 0
    v_mfma_f32_16x16x32_bf16 v[176:179], v[184:187], v[184:187], 0
    ds_read_b128 v[180:183], v1 offset:4096
    s_waitcnt lgkmcnt(6)
    v_mfma_f32_16x16x32_bf16 v[164:167], v[212:215], v[188:191], v[164:167]
    v_mfma_f32_16x16x32_bf16 v[172:175], v[188:191], v[188:191], v[172:175]
    ds_read_b128 v[184:187], v1 offset:24576
    s_waitcnt lgkmcnt(6)
    v_mfma_f32_16x16x32_bf16 v[168:171], v[212:215], v[192:195], v[168:171]
    v_mfma_f32_16x16x32_bf16 v[176:179], v[192:195], v[192:195], v[176:179]
    ds_read_b128 v[188:191], v1 offset:5120
    s_waitcnt lgkmcnt(6)
    v_mfma_f32_16x16x32_bf16 v[164:167], v[212:215], v[196:199], v[164:167]
    v_mfma_f32_16x16x32_bf16 v[172:175], v[196:199], v[196:199], v[172:175]
    ds_read_b128 v[192:195], v1 offset:25600
    s_waitcnt lgkmcnt(6)
    v_mfma_f32_16x16x32_bf16 v[168:171], v[212:215], v[200:203], v[168:171]
    v_mfma_f32_16x16x32_bf16 v[176:179], v[200:203], v[200:203], v[176:179]
    ds_read_b128 v[196:199], v1 offset:6144
    s_waitcnt lgkmcnt(6)
    v_mfma_f32_16x16x32_bf16 v[164:167], v[212:215], v[204:207], v[164:167]
    v_mfma_f32_16x16x32_bf16 v[172:175], v[204:207], v[204:207], v[172:175]
    ds_read_b128 v[200:203], v1 offset:26624
    s_waitcnt lgkmcnt(6)
    v_mfma_f32_16x16x32_bf16 v[168:171], v[212:215], v[208:211], v[168:171]
    v_mfma_f32_16x16x32_bf16 v[176:179], v[208:211], v[208:211], v[176:179]
    ds_read_b128 v[204:207], v1 offset:7168
    s_waitcnt lgkmcnt(6)
    v_mfma_f32_16x16x32_bf16 v[164:167], v[212:215], v[180:183], v[164:167]
    v_mfma_f32_16x16x32_bf16 v[172:175], v[180:183], v[180:183], v[172:175]
    ds_read_b128 v[208:211], v1 offset:27648
    s_waitcnt lgkmcnt(6)
    v_mfma_f32_16x16x32_bf16 v[168:171], v[212:215], v[184:187], v[168:171]
    v_mfma_f32_16x16x32_bf16 v[176:179], v[184:187], v[184:187], v[176:179]
    ds_read_b128 v[180:183], v1 offset:8192
    s_waitcnt lgkmcnt(6)
    v_mfma_f32_16x16x32_bf16 v[164:167], v[212:215], v[188:191], v[164:167]
    v_mfma_f32_16x16x32_bf16 v[172:175], v[188:191], v[188:191], v[172:175]
    ds_read_b128 v[184:187], v1 offset:28672
    s_waitcnt lgkmcnt(6)
    v_mfma_f32_16x16x32_bf16 v[168:171], v[212:215], v[192:195], v[168:171]
    v_mfma_f32_16x16x32_bf16 v[176:179], v[192:195], v[192:195], v[176:179]
    ds_read_b128 v[188:191], v1 offset:9216
    s_waitcnt lgkmcnt(6)
    v_mfma_f32_16x16x32_bf16 v[164:167], v[212:215], v[196:199], v[164:167]
    v_mfma_f32_16x16x32_bf16 v[172:175], v[196:199], v[196:199], v[172:175]
    ds_read_b128 v[192:195], v1 offset:29696
    s_waitcnt lgkmcnt(6)
    v_mfma_f32_16x16x32_bf16 v[168:171], v[212:215], v[200:203], v[168:171]
    v_mfma_f32_16x16x32_bf16 v[176:179], v[200:203], v[200:203], v[176:179]
    ds_read_b128 v[196:199], v1 offset:10240
    s_waitcnt lgkmcnt(6)
    v_mfma_f32_16x16x32_bf16 v[164:167], v[212:215], v[204:207], v[164:167]
    v_mfma_f32_16x16x32_bf16 v[172:175], v[204:207], v[204:207], v[172:175]
    ds_read_b128 v[200:203], v1 offset:30720
    s_waitcnt lgkmcnt(6)
    v_mfma_f32_16x16x32_bf16 v[168:171], v[212:215], v[208:211], v[168:171]
    v_mfma_f32_16x16x32_bf16 v[176:179], v[208:211], v[208:211], v[176:179]
    ds_read_b128 v[204:207], v1 offset:11264
    s_waitcnt lgkmcnt(6)
    v_mfma_f32_16x16x32_bf16 v[164:167], v[212:215], v[180:183], v[164:167]
    v_mfma_f32_16x16x32_bf16 v[172:175], v[180:183], v[180:183], v[172:175]
    ds_read_b128 v[208:211], v1 offset:31744
    s_waitcnt lgkmcnt(6)
    v_mfma_f32_16x16x32_bf16 v[168:171], v[212:215], v[184:187], v[168:171]
    v_mfma_f32_16x16x32_bf16 v[176:179], v[184:187], v[184:187], v[176:179]
    ds_read_b128 v[180:183], v1 offset:12288
    s_waitcnt lgkmcnt(6)
    v_mfma_f32_16x16x32_bf16 v[164:167], v[212:215], v[188:191], v[164:167]
    v_mfma_f32_16x16x32_bf16 v[172:175], v[188:191], v[188:191], v[172:175]
    ds_read_b128 v[184:187], v1 offset:32768
    s_waitcnt lgkmcnt(6)
    v_mfma_f32_16x16x32_bf16 v[168:171], v[212:215], v[192:195], v[168:171]
    v_mfma_f32_16x16x32_bf16 v[176:179], v[192:195], v[192:195], v[176:179]
    ds_read_b128 v[188:191], v1 offset:13312
    s_waitcnt lgkmcnt(6)
    v_mfma_f32_16x16x32_bf16 v[164:167], v[212:215], v[196:199], v[164:167]
    v_mfma_f32_16x16x32_bf16 v[172:175], v[196:199], v[196:199], v[172:175]
    ds_read_b128 v[192:195], v1 offset:33792
    s_waitcnt lgkmcnt(6)
    v_mfma_f32_16x16x32_bf16 v[168:171], v[212:215], v[200:203], v[168:171]
    v_mfma_f32_16x16x32_bf16 v[176:179], v[200:203], v[200:203], v[176:179]
    ds_read_b128 v[196:199], v1 offset:14336
    s_waitcnt lgkmcnt(6)
    v_mfma_f32_16x16x32_bf16 v[164:167], v[212:215], v[204:207], v[164:167]
    v_mfma_f32_16x16x32_bf16 v[172:175], v[204:207], v[204:207], v[172:175]
    ds_read_b128 v[200:203], v1 offset:34816
    s_waitcnt lgkmcnt(6)
    v_mfma_f32_16x16x32_bf16 v[168:171], v[212:215], v[208:211], v[168:171]
    v_mfma_f32_16x16x32_bf16 v[176:179], v[208:211], v[208:211], v[176:179]
    ds_read_b128 v[204:207], v1 offset:15360
    s_waitcnt lgkmcnt(6)
    v_mfma_f32_16x16x32_bf16 v[164:167], v[212:215], v[180:183], v[164:167]
    v_mfma_f32_16x16x32_bf16 v[172:175], v[180:183], v[180:183], v[172:175]
    ds_read_b128 v[208:211], v1 offset:35840
    s_waitcnt lgkmcnt(6)
    v_mfma_f32_16x16x32_bf16 v[168:171], v[212:215], v[184:187], v[168:171]
    v_mfma_f32_16x16x32_bf16 v[176:179], v[184:187], v[184:187], v[176:179]
    ds_read_b128 v[180:183], v1 offset:16384
    s_waitcnt lgkmcnt(6)
    v_mfma_f32_16x16x32_bf16 v[164:167], v[212:215], v[188:191], v[164:167]
    v_mfma_f32_16x16x32_bf16 v[172:175], v[188:191], v[188:191], v[172:175]
    ds_read_b128 v[184:187], v1 offset:36864
    s_waitcnt lgkmcnt(6)
    v_mfma_f32_16x16x32_bf16 v[168:171], v[212:215], v[192:195], v[168:171]
    v_mfma_f32_16x16x32_bf16 v[176:179], v[192:195], v[192:195], v[176:179]
    ds_read_b128 v[188:191], v1 offset:17408
    s_waitcnt lgkmcnt(6)
    v_mfma_f32_16x16x32_bf16 v[164:167], v[212:215], v[196:199], v[164:167]
    v_mfma_f32_16x16x32_bf16 v[172:175], v[196:199], v[196:199], v[172:175]
    ds_read_b128 v[192:195], v1 offset:37888
    s_waitcnt lgkmcnt(6)
    v_mfma_f32_16x16x32_bf16 v[168:171], v[212:215], v[200:203], v[168:171]
    v_mfma_f32_16x16x32_bf16 v[176:179], v[200:203], v[200:203], v[176:179]
    ds_read_b128 v[196:199], v1 offset:18432
    s_waitcnt lgkmcnt(6)
    v_mfma_f32_16x16x32_bf16 v[164:167], v[212:215], v[204:207], v[164:167]
    v_mfma_f32_16x16x32_bf16 v[172:175], v[204:207], v[204:207], v[172:175]
    ds_read_b128 v[200:203], v1 offset:38912
    s_waitcnt lgkmcnt(6)
    v_mfma_f32_16x16x32_bf16 v[168:171], v[212:215], v[208:211], v[168:171]
    v_mfma_f32_16x16x32_bf16 v[176:179], v[208:211], v[208:211], v[176:179]
    ds_read_b128 v[204:207], v1 offset:19456
    s_waitcnt lgkmcnt(6)
    v_mfma_f32_16x16x32_bf16 v[164:167], v[212:215], v[180:183], v[164:167]
    v_mfma_f32_16x16x32_bf16 v[172:175], v[180:183], v[180:183], v[172:175]
    ds_read_b128 v[208:211], v1 offset:39936
    s_waitcnt lgkmcnt(6)
    v_mfma_f32_16x16x32_bf16 v[168:171], v[212:215], v[184:187], v[168:171]
    v_mfma_f32_16x16x32_bf16 v[176:179], v[184:187], v[184:187], v[176:179]
    s_waitcnt lgkmcnt(5)
    v_mfma_f32_16x16x32_bf16 v[164:167], v[212:215], v[188:191], v[164:167]
    v_mfma_f32_16x16x32_bf16 v[172:175], v[188:191], v[188:191], v[172:175]
    s_waitcnt lgkmcnt(4)
    v_mfma_f32_16x16x32_bf16 v[168:171], v[212:215], v[192:195], v[168:171]
    v_mfma_f32_16x16x32_bf16 v[176:179], v[192:195], v[192:195], v[176:179]
    s_waitcnt lgkmcnt(3)
    v_mfma_f32_16x16x32_bf16 v[164:167], v[212:215], v[196:199], v[164:167]
    v_mfma_f32_16x16x32_bf16 v[172:175], v[196:199], v[196:199], v[172:175]
    s_waitcnt lgkmcnt(2)
    v_mfma_f32_16x16x32_bf16 v[168:171], v[212:215], v[200:203], v[168:171]
    v_mfma_f32_16x16x32_bf16 v[176:179], v[200:203], v[200:203], v[176:179]
    s_waitcnt lgkmcnt(1)
    v_mfma_f32_16x16x32_bf16 v[164:167], v[212:215], v[204:207], v[164:167]
    v_mfma_f32_16x16x32_bf16 v[172:175], v[204:207], v[204:207], v[172:175]
    s_waitcnt lgkmcnt(0)
    v_mfma_f32_16x16x32_bf16 v[168:171], v[212:215], v[208:211], v[168:171]
    v_mfma_f32_16x16x32_bf16 v[176:179], v[208:211], v[208:211], v[176:179]
    v_lshlrev_b32 v253, 3, v251
    v_add_u32 v253, 159744, v253
    s_nop 2
    v_cndmask_b32 v172, v172, v173, s[28:29]
    v_cndmask_b32 v172, v172, v174, s[30:31]
    v_cndmask_b32 v172, v172, v175, s[32:33]
    v_mul_f32 v236, 0xbacccccd, v164
    v_mul_f32 v172, 0x3acccccd, v172
    v_fma_f32 v172, -v236, v236, v172
    v_max_f32 v172, 0, v172
    v_add_f32 v172, 0x3727c5ac, v172
    v_rsq_f32 v237, v172
    v_cndmask_b32 v176, v176, v177, s[28:29]
    v_cndmask_b32 v176, v176, v178, s[30:31]
    v_cndmask_b32 v176, v176, v179, s[32:33]
    v_mul_f32 v238, 0xbacccccd, v168
    v_mul_f32 v176, 0x3acccccd, v176
    v_fma_f32 v176, -v238, v238, v176
    v_max_f32 v176, 0, v176
    v_add_f32 v176, 0x3727c5ac, v176
    v_rsq_f32 v239, v176
    s_mov_b64 exec, s[34:35]
    ds_write_b64 v253, v[236:237] offset:256
    ds_write_b64 v253, v[238:239] offset:384
    s_mov_b64 exec, -1
    v_mov_b32 v253, 160256
    v_mov_b32 v254, 1
    s_waitcnt lgkmcnt(0)
    ds_write_b32 v253, v254 offset:8
    s_setprio 0
    s_mov_b32 s42, 0
    s_and_b32 s22, s19, 1
    s_cselect_b32 s41, -1024, 16
    s_lshl_b32 s22, s22, 1
    s_add_u32 s22, s22, s42
    s_lshl_b32 s22, s22, 9
    s_lshr_b32 s23, s19, 1
    s_cselect_b32 s41, s23, s41
    s_add_u32 s41, s41, s22
    s_min_u32 s40, s16, 4
    s_cmp_eq_u32 s16, 6
    s_cselect_b32 s40, 0, s40
    s_lshl_b32 s40, s40, 6
    v_add_u32 v253, s40, v250
    v_mul_u32_u24 v254, 6554, v253
    v_lshrrev_b32 v254, 16, v254
    v_mul_u32_u24 v255, 10, v254
    v_sub_u32 v253, v253, v255
    v_lshrrev_b32 v255, 4, v254
    v_mul_u32_u24 v255, 5120, v255
    v_lshl_add_u32 v255, v253, 9, v255
    v_and_b32 v241, 8, v254
    v_lshl_add_u32 v255, v241, 5, v255
    v_lshl_add_u32 v241, v251, 4, v255
    s_mov_b64 s[42:43], 0
    v_lshl_add_u32 v242, v254, 5, s41
    v_sub_u32 v255, 0x800, v242
    v_cmp_eq_u32 vcc, 0, v242
    v_cndmask_b32 v242, v242, v255, s[42:43]
    v_lshrrev_b32 v255, 1, v242
    v_cndmask_b32 v242, v242, v255, vcc
    v_mul_u32_u24 v242, 1280, v242
    v_lshl_add_u32 v242, v253, 4, v242
    s_mov_b64 s[42:43], -1
    v_lshl_add_u32 v243, v254, 5, s41
    v_sub_u32 v255, 0x800, v243
    v_cmp_eq_u32 vcc, 0, v243
    v_cndmask_b32 v243, v243, v255, s[42:43]
    v_lshrrev_b32 v255, 1, v243
    v_cndmask_b32 v243, v243, v255, vcc
    v_mul_u32_u24 v243, 1280, v243
    v_lshl_add_u32 v243, v253, 4, v243
    s_mul_i32 s41, s16, 10240
    s_add_u32 s41, s41, 40960
    v_lshrrev_b32 v253, 1, v252
    v_lshl_add_u32 v254, v253, 9, s41
    v_and_b32 v255, 8, v251
    v_lshl_add_u32 v254, v255, 5, v254
    v_mad_u32_u24 v253, v251, 10, v253
    v_and_b32 v255, 1, v252
    v_add_u32 v244, 0, v253
    v_and_b32 v244, 15, v244
    v_xor_b32 v244, v244, v255
    v_lshl_add_u32 v244, v244, 4, v254
    v_add_u32 v245, 2, v253
    v_and_b32 v245, 15, v245
    v_xor_b32 v245, v245, v255
    v_lshl_add_u32 v245, v245, 4, v254
    v_add_u32 v246, 4, v253
    v_and_b32 v246, 15, v246
    v_xor_b32 v246, v246, v255
    v_lshl_add_u32 v246, v246, 4, v254
    v_add_u32 v247, 6, v253
    v_and_b32 v247, 15, v247
    v_xor_b32 v247, v247, v255
    v_lshl_add_u32 v247, v247, 4, v254
    v_add_u32 v248, 8, v253
    v_and_b32 v248, 15, v248
    v_xor_b32 v248, v248, v255
    v_lshl_add_u32 v248, v248, 4, v254
    s_mul_i32 s40, s20, 160
    v_lshlrev_b32 v253, 3, v252
    buffer_load_dwordx2 v[180:181], v253, s[48:51], s40 offen offset:0
    buffer_load_dwordx2 v[182:183], v253, s[48:51], s40 offen offset:32
    buffer_load_dwordx2 v[184:185], v253, s[48:51], s40 offen offset:64
    buffer_load_dwordx2 v[186:187], v253, s[48:51], s40 offen offset:96
    buffer_load_dwordx2 v[160:161], v253, s[48:51], s40 offen offset:128
    s_mul_i32 s40, s20, 80
    s_sub_u32 s41, 640, s40
    s_cmp_ge_u32 s20, 4
    s_cselect_b32 s40, s41, s40
    s_cselect_b32 s41, -1, 1
    s_cselect_b32 s42, 7, 0
    s_cselect_b32 s43, 1024, 0
    v_lshlrev_b32 v253, 2, v252
    v_mul_lo_u32 v253, v253, s41
    v_add_u32 v253, s40, v253
    v_lshl_add_u32 v236, v251, 4, s43
    s_mul_i32 s45, s41, 0
    v_add_u32 v255, s45, v253
    v_cmp_ne_u32 vcc, 320, v255
    s_nop 1
    v_cndmask_b32 v255, 0, v255, vcc
    v_lshrrev_b32 v254, 5, v255
    v_lshl_add_u32 v4, v254, 11, v236
    v_and_b32 v254, 24, v255
    v_lshl_add_u32 v4, v254, 5, v4
    v_and_b32 v254, 7, v255
    v_xor_b32 v254, s42, v254
    v_lshl_add_u32 v4, v254, 1, v4
    s_mul_i32 s45, s41, 1
    v_add_u32 v255, s45, v253
    v_lshrrev_b32 v254, 5, v255
    v_lshl_add_u32 v5, v254, 11, v236
    v_and_b32 v254, 24, v255
    v_lshl_add_u32 v5, v254, 5, v5
    v_and_b32 v254, 7, v255
    v_xor_b32 v254, s42, v254
    v_lshl_add_u32 v5, v254, 1, v5
    s_mul_i32 s45, s41, 2
    v_add_u32 v255, s45, v253
    v_lshrrev_b32 v254, 5, v255
    v_lshl_add_u32 v6, v254, 11, v236
    v_and_b32 v254, 24, v255
    v_lshl_add_u32 v6, v254, 5, v6
    v_and_b32 v254, 7, v255
    v_xor_b32 v254, s42, v254
    v_lshl_add_u32 v6, v254, 1, v6
    s_mul_i32 s45, s41, 3
    v_add_u32 v255, s45, v253
    v_lshrrev_b32 v254, 5, v255
    v_lshl_add_u32 v7, v254, 11, v236
    v_and_b32 v254, 24, v255
    v_lshl_add_u32 v7, v254, 5, v7
    v_and_b32 v254, 7, v255
    v_xor_b32 v254, s42, v254
    v_lshl_add_u32 v7, v254, 1, v7
    s_mul_i32 s45, s41, 16
    v_add_u32 v255, s45, v253
    v_lshrrev_b32 v254, 5, v255
    v_lshl_add_u32 v8, v254, 11, v236
    v_and_b32 v254, 24, v255
    v_lshl_add_u32 v8, v254, 5, v8
    v_and_b32 v254, 7, v255
    v_xor_b32 v254, s42, v254
    v_lshl_add_u32 v8, v254, 1, v8
    s_mul_i32 s45, s41, 17
    v_add_u32 v255, s45, v253
    v_lshrrev_b32 v254, 5, v255
    v_lshl_add_u32 v9, v254, 11, v236
    v_and_b32 v254, 24, v255
    v_lshl_add_u32 v9, v254, 5, v9
    v_and_b32 v254, 7, v255
    v_xor_b32 v254, s42, v254
    v_lshl_add_u32 v9, v254, 1, v9
    s_mul_i32 s45, s41, 18
    v_add_u32 v255, s45, v253
    v_lshrrev_b32 v254, 5, v255
    v_lshl_add_u32 v10, v254, 11, v236
    v_and_b32 v254, 24, v255
    v_lshl_add_u32 v10, v254, 5, v10
    v_and_b32 v254, 7, v255
    v_xor_b32 v254, s42, v254
    v_lshl_add_u32 v10, v254, 1, v10
    s_mul_i32 s45, s41, 19
    v_add_u32 v255, s45, v253
    v_lshrrev_b32 v254, 5, v255
    v_lshl_add_u32 v11, v254, 11, v236
    v_and_b32 v254, 24, v255
    v_lshl_add_u32 v11, v254, 5, v11
    v_and_b32 v254, 7, v255
    v_xor_b32 v254, s42, v254
    v_lshl_add_u32 v11, v254, 1, v11
    s_mul_i32 s45, s41, 32
    v_add_u32 v255, s45, v253
    v_lshrrev_b32 v254, 5, v255
    v_lshl_add_u32 v12, v254, 11, v236
    v_and_b32 v254, 24, v255
    v_lshl_add_u32 v12, v254, 5, v12
    v_and_b32 v254, 7, v255
    v_xor_b32 v254, s42, v254
    v_lshl_add_u32 v12, v254, 1, v12
    s_mul_i32 s45, s41, 33
    v_add_u32 v255, s45, v253
    v_lshrrev_b32 v254, 5, v255
    v_lshl_add_u32 v13, v254, 11, v236
    v_and_b32 v254, 24, v255
    v_lshl_add_u32 v13, v254, 5, v13
    v_and_b32 v254, 7, v255
    v_xor_b32 v254, s42, v254
    v_lshl_add_u32 v13, v254, 1, v13
    s_mul_i32 s45, s41, 34
    v_add_u32 v255, s45, v253
    v_lshrrev_b32 v254, 5, v255
    v_lshl_add_u32 v14, v254, 11, v236
    v_and_b32 v254, 24, v255
    v_lshl_add_u32 v14, v254, 5, v14
    v_and_b32 v254, 7, v255
    v_xor_b32 v254, s42, v254
    v_lshl_add_u32 v14, v254, 1, v14
    s_mul_i32 s45, s41, 35
    v_add_u32 v255, s45, v253
    v_lshrrev_b32 v254, 5, v255
    v_lshl_add_u32 v15, v254, 11, v236
    v_and_b32 v254, 24, v255
    v_lshl_add_u32 v15, v254, 5, v15
    v_and_b32 v254, 7, v255
    v_xor_b32 v254, s42, v254
    v_lshl_add_u32 v15, v254, 1, v15
    s_mul_i32 s45, s41, 48
    v_add_u32 v255, s45, v253
    v_lshrrev_b32 v254, 5, v255
    v_lshl_add_u32 v16, v254, 11, v236
    v_and_b32 v254, 24, v255
    v_lshl_add_u32 v16, v254, 5, v16
    v_and_b32 v254, 7, v255
    v_xor_b32 v254, s42, v254
    v_lshl_add_u32 v16, v254, 1, v16
    s_mul_i32 s45, s41, 49
    v_add_u32 v255, s45, v253
    v_lshrrev_b32 v254, 5, v255
    v_lshl_add_u32 v17, v254, 11, v236
    v_and_b32 v254, 24, v255
    v_lshl_add_u32 v17, v254, 5, v17
    v_and_b32 v254, 7, v255
    v_xor_b32 v254, s42, v254
    v_lshl_add_u32 v17, v254, 1, v17
    s_mul_i32 s45, s41, 50
    v_add_u32 v255, s45, v253
    v_lshrrev_b32 v254, 5, v255
    v_lshl_add_u32 v18, v254, 11, v236
    v_and_b32 v254, 24, v255
    v_lshl_add_u32 v18, v254, 5, v18
    v_and_b32 v254, 7, v255
    v_xor_b32 v254, s42, v254
    v_lshl_add_u32 v18, v254, 1, v18
    s_mul_i32 s45, s41, 51
    v_add_u32 v255, s45, v253
    v_lshrrev_b32 v254, 5, v255
    v_lshl_add_u32 v19, v254, 11, v236
    v_and_b32 v254, 24, v255
    v_lshl_add_u32 v19, v254, 5, v19
    v_and_b32 v254, 7, v255
    v_xor_b32 v254, s42, v254
    v_lshl_add_u32 v19, v254, 1, v19
    s_mul_i32 s45, s41, 64
    v_add_u32 v255, s45, v253
    v_lshrrev_b32 v254, 5, v255
    v_lshl_add_u32 v20, v254, 11, v236
    v_and_b32 v254, 24, v255
    v_lshl_add_u32 v20, v254, 5, v20
    v_and_b32 v254, 7, v255
    v_xor_b32 v254, s42, v254
    v_lshl_add_u32 v20, v254, 1, v20
    s_mul_i32 s45, s41, 65
    v_add_u32 v255, s45, v253
    v_lshrrev_b32 v254, 5, v255
    v_lshl_add_u32 v21, v254, 11, v236
    v_and_b32 v254, 24, v255
    v_lshl_add_u32 v21, v254, 5, v21
    v_and_b32 v254, 7, v255
    v_xor_b32 v254, s42, v254
    v_lshl_add_u32 v21, v254, 1, v21
    s_mul_i32 s45, s41, 66
    v_add_u32 v255, s45, v253
    v_lshrrev_b32 v254, 5, v255
    v_lshl_add_u32 v22, v254, 11, v236
    v_and_b32 v254, 24, v255
    v_lshl_add_u32 v22, v254, 5, v22
    v_and_b32 v254, 7, v255
    v_xor_b32 v254, s42, v254
    v_lshl_add_u32 v22, v254, 1, v22
    s_mul_i32 s45, s41, 67
    v_add_u32 v255, s45, v253
    v_lshrrev_b32 v254, 5, v255
    v_lshl_add_u32 v23, v254, 11, v236
    v_and_b32 v254, 24, v255
    v_lshl_add_u32 v23, v254, 5, v23
    v_and_b32 v254, 7, v255
    v_xor_b32 v254, s42, v254
    v_lshl_add_u32 v23, v254, 1, v23
    s_waitcnt lgkmcnt(0)
    v_mov_b32 v164, 0
    v_mov_b32 v165, 0
    v_mov_b32 v166, 0
    v_mov_b32 v167, 0
    v_mov_b32 v168, 0
    v_mov_b32 v169, 0
    v_mov_b32 v170, 0
    v_mov_b32 v171, 0
    v_mov_b32 v172, 0
    v_mov_b32 v173, 0
    v_mov_b32 v174, 0
    v_mov_b32 v175, 0
    v_mov_b32 v176, 0
    v_mov_b32 v177, 0
    v_mov_b32 v178, 0
    v_mov_b32 v179, 0
    v_mov_b32 v220, 0
    v_mov_b32 v221, 0
    v_mov_b32 v222, 0
    v_mov_b32 v223, 0
    v_mov_b32 v224, 0
    v_mov_b32 v225, 0
    v_mov_b32 v226, 0
    v_mov_b32 v227, 0
    v_mov_b32 v228, 0
    v_mov_b32 v229, 0
    v_mov_b32 v230, 0
    v_mov_b32 v231, 0
    v_mov_b32 v232, 0
    v_mov_b32 v233, 0
    v_mov_b32 v234, 0
    v_mov_b32 v235, 0
    v_mov_b32 v144, 0
    v_mov_b32 v145, 0
    v_mov_b32 v146, 0
    v_mov_b32 v147, 0
    v_mov_b32 v148, 0
    v_mov_b32 v149, 0
    v_mov_b32 v150, 0
    v_mov_b32 v151, 0
    ds_read_u16_d16_hi v164, v4 offset:40960
    ds_read_u16_d16_hi v224, v4 offset:61440
    ds_read_u16_d16_hi v165, v5 offset:40960
    ds_read_u16_d16_hi v225, v5 offset:61440
    ds_read_u16_d16_hi v166, v6 offset:40960
    ds_read_u16_d16_hi v226, v6 offset:61440
    ds_read_u16_d16_hi v167, v7 offset:40960
    ds_read_u16_d16_hi v227, v7 offset:61440
    ds_read_u16_d16_hi v168, v8 offset:40960
    ds_read_u16_d16_hi v228, v8 offset:61440
    ds_read_u16_d16_hi v169, v9 offset:40960
    ds_read_u16_d16_hi v229, v9 offset:61440
    ds_read_u16_d16_hi v170, v10 offset:40960
    ds_read_u16_d16_hi v230, v10 offset:61440
    ds_read_u16_d16_hi v171, v11 offset:40960
    ds_read_u16_d16_hi v231, v11 offset:61440
    ds_read_u16_d16_hi v172, v12 offset:40960
    ds_read_u16_d16_hi v232, v12 offset:61440
    ds_read_u16_d16_hi v173, v13 offset:40960
    ds_read_u16_d16_hi v233, v13 offset:61440
    ds_read_u16_d16_hi v174, v14 offset:40960
    ds_read_u16_d16_hi v234, v14 offset:61440
    ds_read_u16_d16_hi v175, v15 offset:40960
    ds_read_u16_d16_hi v235, v15 offset:61440
    ds_read_u16_d16_hi v176, v16 offset:40960
    ds_read_u16_d16_hi v144, v16 offset:61440
    ds_read_u16_d16_hi v177, v17 offset:40960
    ds_read_u16_d16_hi v145, v17 offset:61440
    ds_read_u16_d16_hi v178, v18 offset:40960
    ds_read_u16_d16_hi v146, v18 offset:61440
    ds_read_u16_d16_hi v179, v19 offset:40960
    ds_read_u16_d16_hi v147, v19 offset:61440
    ds_read_u16_d16_hi v220, v20 offset:40960
    ds_read_u16_d16_hi v148, v20 offset:61440
    ds_read_u16_d16_hi v221, v21 offset:40960
    ds_read_u16_d16_hi v149, v21 offset:61440
    ds_read_u16_d16_hi v222, v22 offset:40960
    ds_read_u16_d16_hi v150, v22 offset:61440
    ds_read_u16_d16_hi v223, v23 offset:40960
    ds_read_u16_d16_hi v151, v23 offset:61440
    s_waitcnt lgkmcnt(0)
    s_waitcnt vmcnt(4)
    v_lshlrev_b32 v254, 16, v180
    v_and_b32 v255, 0xffff0000, v180
    v_add_f32 v164, v164, v254
    v_add_f32 v165, v165, v255
    v_add_f32 v224, v224, v254
    v_add_f32 v225, v225, v255
    v_lshlrev_b32 v254, 16, v181
    v_and_b32 v255, 0xffff0000, v181
    v_add_f32 v166, v166, v254
    v_add_f32 v167, v167, v255
    v_add_f32 v226, v226, v254
    v_add_f32 v227, v227, v255
    s_waitcnt vmcnt(3)
    v_lshlrev_b32 v254, 16, v182
    v_and_b32 v255, 0xffff0000, v182
    v_add_f32 v168, v168, v254
    v_add_f32 v169, v169, v255
    v_add_f32 v228, v228, v254
    v_add_f32 v229, v229, v255
    v_lshlrev_b32 v254, 16, v183
    v_and_b32 v255, 0xffff0000, v183
    v_add_f32 v170, v170, v254
    v_add_f32 v171, v171, v255
    v_add_f32 v230, v230, v254
    v_add_f32 v231, v231, v255
    s_waitcnt vmcnt(2)
    v_lshlrev_b32 v254, 16, v184
    v_and_b32 v255, 0xffff0000, v184
    v_add_f32 v172, v172, v254
    v_add_f32 v173, v173, v255
    v_add_f32 v232, v232, v254
    v_add_f32 v233, v233, v255
    v_lshlrev_b32 v254, 16, v185
    v_and_b32 v255, 0xffff0000, v185
    v_add_f32 v174, v174, v254
    v_add_f32 v175, v175, v255
    v_add_f32 v234, v234, v254
    v_add_f32 v235, v235, v255
    s_waitcnt vmcnt(1)
    v_lshlrev_b32 v254, 16, v186
    v_and_b32 v255, 0xffff0000, v186
    v_add_f32 v176, v176, v254
    v_add_f32 v177, v177, v255
    v_add_f32 v144, v144, v254
    v_add_f32 v145, v145, v255
    v_lshlrev_b32 v254, 16, v187
    v_and_b32 v255, 0xffff0000, v187
    v_add_f32 v178, v178, v254
    v_add_f32 v179, v179, v255
    v_add_f32 v146, v146, v254
    v_add_f32 v147, v147, v255
    s_waitcnt vmcnt(0)
    v_lshlrev_b32 v254, 16, v160
    v_and_b32 v255, 0xffff0000, v160
    v_add_f32 v220, v220, v254
    v_add_f32 v221, v221, v255
    v_add_f32 v148, v148, v254
    v_add_f32 v149, v149, v255
    v_lshlrev_b32 v254, 16, v161
    v_and_b32 v255, 0xffff0000, v161
    v_add_f32 v222, v222, v254
    v_add_f32 v223, v223, v255
    v_add_f32 v150, v150, v254
    v_add_f32 v151, v151, v255
    v_mov_b32 v253, 160256
    v_mov_b32 v254, 1
    s_mov_b64 exec, 1
    ds_add_u32 v253, v254
    s_mov_b64 exec, -1
    s_setprio 1
    s_load_dwordx8 s[32:39], s[8:9], s90 glc
    s_mov_b32 s41, 0x8000
K2_PSw0:
    s_waitcnt lgkmcnt(0)
    s_mov_b32 s32, s38
    s_and_b64 s[34:35], s[34:35], s[36:37]
    s_and_b64 s[32:33], s[32:33], s[34:35]
    s_and_b32 s33, s33, s32
    s_cbranch_scc1 K2_PDw0
    s_load_dwordx8 s[32:39], s[8:9], s90 glc
    s_sub_u32 s41, s41, 1
    s_cbranch_scc0 K2_PSw0
    s_waitcnt lgkmcnt(0)
K2_PDw0:
    s_lshl_b32 s56, s93, 11
    s_add_u32 s56, s56, s101
    buffer_load_dwordx4 v[188:191], v1, s[8:11], s56 offen offset:0 sc1
    buffer_load_dwordx4 v[192:195], v1, s[8:11], s56 offen offset:1024 sc1
    s_lshl_b32 s56, s94, 11
    s_add_u32 s56, s56, s101
    buffer_load_dwordx4 v[196:199], v1, s[8:11], s56 offen offset:0 sc1
    buffer_load_dwordx4 v[200:203], v1, s[8:11], s56 offen offset:1024 sc1
    s_lshl_b32 s56, s95, 11
    s_add_u32 s56, s56, s101
    buffer_load_dwordx4 v[204:207], v1, s[8:11], s56 offen offset:0 sc1
    buffer_load_dwordx4 v[208:211], v1, s[8:11], s56 offen offset:1024 sc1
    s_lshl_b32 s56, s96, 11
    s_add_u32 s56, s56, s101
    buffer_load_dwordx4 v[152:155], v1, s[8:11], s56 offen offset:0 sc1
    buffer_load_dwordx4 v[156:159], v1, s[8:11], s56 offen offset:1024 sc1
    s_lshl_b32 s56, s97, 11
    s_add_u32 s56, s56, s101
    buffer_load_dwordx4 v[212:215], v1, s[8:11], s56 offen offset:0 sc1
    buffer_load_dwordx4 v[216:219], v1, s[8:11], s56 offen offset:1024 sc1
    s_waitcnt vmcnt(9)
    v_mfma_f32_16x16x32_bf16 v[164:167], v[24:27], v[188:191], v[164:167]
    v_mfma_f32_16x16x32_bf16 v[168:171], v[28:31], v[188:191], v[168:171]
    v_mfma_f32_16x16x32_bf16 v[172:175], v[32:35], v[188:191], v[172:175]
    v_mfma_f32_16x16x32_bf16 v[176:179], v[36:39], v[188:191], v[176:179]
    v_mfma_f32_16x16x32_bf16 v[220:223], v[40:43], v[188:191], v[220:223]
    s_waitcnt vmcnt(8)
    v_mfma_f32_16x16x32_bf16 v[224:227], v[24:27], v[192:195], v[224:227]
    v_mfma_f32_16x16x32_bf16 v[228:231], v[28:31], v[192:195], v[228:231]
    v_mfma_f32_16x16x32_bf16 v[232:235], v[32:35], v[192:195], v[232:235]
    v_mfma_f32_16x16x32_bf16 v[144:147], v[36:39], v[192:195], v[144:147]
    v_mfma_f32_16x16x32_bf16 v[148:151], v[40:43], v[192:195], v[148:151]
    s_lshl_b32 s56, s98, 11
    s_add_u32 s56, s56, s101
    buffer_load_dwordx4 v[188:191], v1, s[8:11], s56 offen offset:0 sc1
    buffer_load_dwordx4 v[192:195], v1, s[8:11], s56 offen offset:1024 sc1
    s_waitcnt vmcnt(9)
    v_mfma_f32_16x16x32_bf16 v[164:167], v[44:47], v[196:199], v[164:167]
    v_mfma_f32_16x16x32_bf16 v[168:171], v[48:51], v[196:199], v[168:171]
    v_mfma_f32_16x16x32_bf16 v[172:175], v[52:55], v[196:199], v[172:175]
    v_mfma_f32_16x16x32_bf16 v[176:179], v[56:59], v[196:199], v[176:179]
    v_mfma_f32_16x16x32_bf16 v[220:223], v[60:63], v[196:199], v[220:223]
    s_waitcnt vmcnt(8)
    v_mfma_f32_16x16x32_bf16 v[224:227], v[44:47], v[200:203], v[224:227]
    v_mfma_f32_16x16x32_bf16 v[228:231], v[48:51], v[200:203], v[228:231]
    v_mfma_f32_16x16x32_bf16 v[232:235], v[52:55], v[200:203], v[232:235]
    v_mfma_f32_16x16x32_bf16 v[144:147], v[56:59], v[200:203], v[144:147]
    v_mfma_f32_16x16x32_bf16 v[148:151], v[60:63], v[200:203], v[148:151]
    s_waitcnt vmcnt(7)
    v_mfma_f32_16x16x32_bf16 v[164:167], v[64:67], v[204:207], v[164:167]
    v_mfma_f32_16x16x32_bf16 v[168:171], v[68:71], v[204:207], v[168:171]
    v_mfma_f32_16x16x32_bf16 v[172:175], v[72:75], v[204:207], v[172:175]
    v_mfma_f32_16x16x32_bf16 v[176:179], v[76:79], v[204:207], v[176:179]
    v_mfma_f32_16x16x32_bf16 v[220:223], v[80:83], v[204:207], v[220:223]
    s_waitcnt vmcnt(6)
    v_mfma_f32_16x16x32_bf16 v[224:227], v[64:67], v[208:211], v[224:227]
    v_mfma_f32_16x16x32_bf16 v[228:231], v[68:71], v[208:211], v[228:231]
    v_mfma_f32_16x16x32_bf16 v[232:235], v[72:75], v[208:211], v[232:235]
    v_mfma_f32_16x16x32_bf16 v[144:147], v[76:79], v[208:211], v[144:147]
    v_mfma_f32_16x16x32_bf16 v[148:151], v[80:83], v[208:211], v[148:151]
    s_waitcnt vmcnt(5)
    v_mfma_f32_16x16x32_bf16 v[164:167], v[84:87], v[152:155], v[164:167]
    v_mfma_f32_16x16x32_bf16 v[168:171], v[88:91], v[152:155], v[168:171]
    v_mfma_f32_16x16x32_bf16 v[172:175], v[92:95], v[152:155], v[172:175]
    v_mfma_f32_16x16x32_bf16 v[176:179], v[96:99], v[152:155], v[176:179]
    v_mfma_f32_16x16x32_bf16 v[220:223], v[100:103], v[152:155], v[220:223]
    s_waitcnt vmcnt(4)
    v_mfma_f32_16x16x32_bf16 v[224:227], v[84:87], v[156:159], v[224:227]
    v_mfma_f32_16x16x32_bf16 v[228:231], v[88:91], v[156:159], v[228:231]
    v_mfma_f32_16x16x32_bf16 v[232:235], v[92:95], v[156:159], v[232:235]
    v_mfma_f32_16x16x32_bf16 v[144:147], v[96:99], v[156:159], v[144:147]
    v_mfma_f32_16x16x32_bf16 v[148:151], v[100:103], v[156:159], v[148:151]
    s_waitcnt vmcnt(3)
    v_mfma_f32_16x16x32_bf16 v[164:167], v[104:107], v[212:215], v[164:167]
    v_mfma_f32_16x16x32_bf16 v[168:171], v[108:111], v[212:215], v[168:171]
    v_mfma_f32_16x16x32_bf16 v[172:175], v[112:115], v[212:215], v[172:175]
    v_mfma_f32_16x16x32_bf16 v[176:179], v[116:119], v[212:215], v[176:179]
    v_mfma_f32_16x16x32_bf16 v[220:223], v[120:123], v[212:215], v[220:223]
    s_waitcnt vmcnt(2)
    v_mfma_f32_16x16x32_bf16 v[224:227], v[104:107], v[216:219], v[224:227]
    v_mfma_f32_16x16x32_bf16 v[228:231], v[108:111], v[216:219], v[228:231]
    v_mfma_f32_16x16x32_bf16 v[232:235], v[112:115], v[216:219], v[232:235]
    v_mfma_f32_16x16x32_bf16 v[144:147], v[116:119], v[216:219], v[144:147]
    v_mfma_f32_16x16x32_bf16 v[148:151], v[120:123], v[216:219], v[148:151]
    s_waitcnt vmcnt(1)
    v_mfma_f32_16x16x32_bf16 v[164:167], v[124:127], v[188:191], v[164:167]
    v_mfma_f32_16x16x32_bf16 v[168:171], v[128:131], v[188:191], v[168:171]
    v_mfma_f32_16x16x32_bf16 v[172:175], v[132:135], v[188:191], v[172:175]
    v_mfma_f32_16x16x32_bf16 v[176:179], v[136:139], v[188:191], v[176:179]
    v_mfma_f32_16x16x32_bf16 v[220:223], v[140:143], v[188:191], v[220:223]
    s_waitcnt vmcnt(0)
    v_mfma_f32_16x16x32_bf16 v[224:227], v[124:127], v[192:195], v[224:227]
    v_mfma_f32_16x16x32_bf16 v[228:231], v[128:131], v[192:195], v[228:231]
    v_mfma_f32_16x16x32_bf16 v[232:235], v[132:135], v[192:195], v[232:235]
    v_mfma_f32_16x16x32_bf16 v[144:147], v[136:139], v[192:195], v[144:147]
    v_mfma_f32_16x16x32_bf16 v[148:151], v[140:143], v[192:195], v[148:151]
    s_setprio 0
    v_mov_b32 v253, 160256
K2_CWw:
    ds_read_b32 v254, v253 offset:0
    s_waitcnt lgkmcnt(0)
    v_cmp_ne_u32 vcc, 8, v254
    s_cbranch_vccnz K2_CWw
    ds_write_b128 v244, v[164:167] offset:0
    ds_write_b128 v245, v[168:171] offset:1024
    ds_write_b128 v246, v[172:175] offset:2048
    ds_write_b128 v247, v[176:179] offset:3072
    ds_write_b128 v248, v[220:223] offset:4096
    ds_write_b128 v244, v[224:227] offset:5120
    ds_write_b128 v245, v[228:231] offset:6144
    ds_write_b128 v246, v[232:235] offset:7168
    ds_write_b128 v247, v[144:147] offset:8192
    ds_write_b128 v248, v[148:151] offset:9216
    s_cmp_lt_u32 s16, 4
    s_cselect_b32 s41, -1, 1
    s_mul_i32 s41, s41, 40960
    s_waitcnt lgkmcnt(0)
    v_mov_b32 v164, 0
    v_mov_b32 v165, 0
    v_mov_b32 v166, 0
    v_mov_b32 v167, 0
    v_mov_b32 v168, 0
    v_mov_b32 v169, 0
    v_mov_b32 v170, 0
    v_mov_b32 v171, 0
    v_mov_b32 v172, 0
    v_mov_b32 v173, 0
    v_mov_b32 v174, 0
    v_mov_b32 v175, 0
    v_mov_b32 v176, 0
    v_mov_b32 v177, 0
    v_mov_b32 v178, 0
    v_mov_b32 v179, 0
    v_mov_b32 v220, 0
    v_mov_b32 v221, 0
    v_mov_b32 v222, 0
    v_mov_b32 v223, 0
    v_mov_b32 v224, 0
    v_mov_b32 v225, 0
    v_mov_b32 v226, 0
    v_mov_b32 v227, 0
    v_mov_b32 v228, 0
    v_mov_b32 v229, 0
    v_mov_b32 v230, 0
    v_mov_b32 v231, 0
    v_mov_b32 v232, 0
    v_mov_b32 v233, 0
    v_mov_b32 v234, 0
    v_mov_b32 v235, 0
    v_mov_b32 v144, 0
    v_mov_b32 v145, 0
    v_mov_b32 v146, 0
    v_mov_b32 v147, 0
    v_mov_b32 v148, 0
    v_mov_b32 v149, 0
    v_mov_b32 v150, 0
    v_mov_b32 v151, 0
    ds_read_u16_d16_hi v164, v4 offset:0
    ds_read_u16_d16_hi v224, v4 offset:20480
    ds_read_u16_d16_hi v165, v5 offset:0
    ds_read_u16_d16_hi v225, v5 offset:20480
    ds_read_u16_d16_hi v166, v6 offset:0
    ds_read_u16_d16_hi v226, v6 offset:20480
    ds_read_u16_d16_hi v167, v7 offset:0
    ds_read_u16_d16_hi v227, v7 offset:20480
    ds_read_u16_d16_hi v168, v8 offset:0
    ds_read_u16_d16_hi v228, v8 offset:20480
    ds_read_u16_d16_hi v169, v9 offset:0
    ds_read_u16_d16_hi v229, v9 offset:20480
    ds_read_u16_d16_hi v170, v10 offset:0
    ds_read_u16_d16_hi v230, v10 offset:20480
    ds_read_u16_d16_hi v171, v11 offset:0
    ds_read_u16_d16_hi v231, v11 offset:20480
    ds_read_u16_d16_hi v172, v12 offset:0
    ds_read_u16_d16_hi v232, v12 offset:20480
    ds_read_u16_d16_hi v173, v13 offset:0
    ds_read_u16_d16_hi v233, v13 offset:20480
    ds_read_u16_d16_hi v174, v14 offset:0
    ds_read_u16_d16_hi v234, v14 offset:20480
    ds_read_u16_d16_hi v175, v15 offset:0
    ds_read_u16_d16_hi v235, v15 offset:20480
    ds_read_u16_d16_hi v176, v16 offset:0
    ds_read_u16_d16_hi v144, v16 offset:20480
    ds_read_u16_d16_hi v177, v17 offset:0
    ds_read_u16_d16_hi v145, v17 offset:20480
    ds_read_u16_d16_hi v178, v18 offset:0
    ds_read_u16_d16_hi v146, v18 offset:20480
    ds_read_u16_d16_hi v179, v19 offset:0
    ds_read_u16_d16_hi v147, v19 offset:20480
    ds_read_u16_d16_hi v220, v20 offset:0
    ds_read_u16_d16_hi v148, v20 offset:20480
    ds_read_u16_d16_hi v221, v21 offset:0
    ds_read_u16_d16_hi v149, v21 offset:20480
    ds_read_u16_d16_hi v222, v22 offset:0
    ds_read_u16_d16_hi v150, v22 offset:20480
    ds_read_u16_d16_hi v223, v23 offset:0
    ds_read_u16_d16_hi v151, v23 offset:20480
    s_waitcnt lgkmcnt(0)
    v_lshlrev_b32 v254, 16, v180
    v_and_b32 v255, 0xffff0000, v180
    v_add_f32 v164, v164, v254
    v_add_f32 v165, v165, v255
    v_add_f32 v224, v224, v254
    v_add_f32 v225, v225, v255
    v_lshlrev_b32 v254, 16, v181
    v_and_b32 v255, 0xffff0000, v181
    v_add_f32 v166, v166, v254
    v_add_f32 v167, v167, v255
    v_add_f32 v226, v226, v254
    v_add_f32 v227, v227, v255
    v_lshlrev_b32 v254, 16, v182
    v_and_b32 v255, 0xffff0000, v182
    v_add_f32 v168, v168, v254
    v_add_f32 v169, v169, v255
    v_add_f32 v228, v228, v254
    v_add_f32 v229, v229, v255
    v_lshlrev_b32 v254, 16, v183
    v_and_b32 v255, 0xffff0000, v183
    v_add_f32 v170, v170, v254
    v_add_f32 v171, v171, v255
    v_add_f32 v230, v230, v254
    v_add_f32 v231, v231, v255
    v_lshlrev_b32 v254, 16, v184
    v_and_b32 v255, 0xffff0000, v184
    v_add_f32 v172, v172, v254
    v_add_f32 v173, v173, v255
    v_add_f32 v232, v232, v254
    v_add_f32 v233, v233, v255
    v_lshlrev_b32 v254, 16, v185
    v_and_b32 v255, 0xffff0000, v185
    v_add_f32 v174, v174, v254
    v_add_f32 v175, v175, v255
    v_add_f32 v234, v234, v254
    v_add_f32 v235, v235, v255
    v_lshlrev_b32 v254, 16, v186
    v_and_b32 v255, 0xffff0000, v186
    v_add_f32 v176, v176, v254
    v_add_f32 v177, v177, v255
    v_add_f32 v144, v144, v254
    v_add_f32 v145, v145, v255
    v_lshlrev_b32 v254, 16, v187
    v_and_b32 v255, 0xffff0000, v187
    v_add_f32 v178, v178, v254
    v_add_f32 v179, v179, v255
    v_add_f32 v146, v146, v254
    v_add_f32 v147, v147, v255
    v_lshlrev_b32 v254, 16, v160
    v_and_b32 v255, 0xffff0000, v160
    v_add_f32 v220, v220, v254
    v_add_f32 v221, v221, v255
    v_add_f32 v148, v148, v254
    v_add_f32 v149, v149, v255
    v_lshlrev_b32 v254, 16, v161
    v_and_b32 v255, 0xffff0000, v161
    v_add_f32 v222, v222, v254
    v_add_f32 v223, v223, v255
    v_add_f32 v150, v150, v254
    v_add_f32 v151, v151, v255
    s_mov_b32 s45, s41
    s_add_u32 s90, s90, 64
    s_load_dwordx8 s[32:39], s[8:9], s90 glc
    s_mov_b32 s41, 0x8000
K2_PSw1:
    s_waitcnt lgkmcnt(0)
    s_mov_b32 s32, s38
    s_and_b64 s[34:35], s[34:35], s[36:37]
    s_and_b64 s[32:33], s[32:33], s[34:35]
    s_and_b32 s33, s33, s32
    s_cbranch_scc1 K2_PDw1
    s_load_dwordx8 s[32:39], s[8:9], s90 glc
    s_sub_u32 s41, s41, 1
    s_cbranch_scc0 K2_PSw1
    s_waitcnt lgkmcnt(0)
K2_PDw1:
    s_mov_b32 s41, s45
    s_lshl_b32 s56, s93, 11
    s_add_u32 s56, s56, s101
    s_add_u32 s56, s56, 110592
    buffer_load_dwordx4 v[196:199], v1, s[8:11], s56 offen offset:0 sc1
    buffer_load_dwordx4 v[200:203], v1, s[8:11], s56 offen offset:1024 sc1
    s_lshl_b32 s56, s94, 11
    s_add_u32 s56, s56, s101
    s_add_u32 s56, s56, 110592
    buffer_load_dwordx4 v[204:207], v1, s[8:11], s56 offen offset:0 sc1
    buffer_load_dwordx4 v[208:211], v1, s[8:11], s56 offen offset:1024 sc1
    s_lshl_b32 s56, s95, 11
    s_add_u32 s56, s56, s101
    s_add_u32 s56, s56, 110592
    buffer_load_dwordx4 v[152:155], v1, s[8:11], s56 offen offset:0 sc1
    buffer_load_dwordx4 v[156:159], v1, s[8:11], s56 offen offset:1024 sc1
    s_lshl_b32 s56, s96, 11
    s_add_u32 s56, s56, s101
    s_add_u32 s56, s56, 110592
    buffer_load_dwordx4 v[212:215], v1, s[8:11], s56 offen offset:0 sc1
    buffer_load_dwordx4 v[216:219], v1, s[8:11], s56 offen offset:1024 sc1
    s_lshl_b32 s56, s97, 11
    s_add_u32 s56, s56, s101
    s_add_u32 s56, s56, 110592
    buffer_load_dwordx4 v[188:191], v1, s[8:11], s56 offen offset:0 sc1
    buffer_load_dwordx4 v[192:195], v1, s[8:11], s56 offen offset:1024 sc1
    s_lshl_b32 s56, s98, 11
    s_add_u32 s56, s56, s101
    s_add_u32 s56, s56, 110592
    buffer_load_dwordx4 v[180:183], v1, s[8:11], s56 offen offset:0 sc1
    buffer_load_dwordx4 v[184:187], v1, s[8:11], s56 offen offset:1024 sc1
    s_waitcnt lgkmcnt(0)
    v_add_u32 v244, s41, v244
    v_add_u32 v245, s41, v245
    v_add_u32 v246, s41, v246
    v_add_u32 v247, s41, v247
    v_add_u32 v248, s41, v248
    s_waitcnt vmcnt(11)
    v_mfma_f32_16x16x32_bf16 v[164:167], v[24:27], v[196:199], v[164:167]
    v_mfma_f32_16x16x32_bf16 v[168:171], v[28:31], v[196:199], v[168:171]
    v_mfma_f32_16x16x32_bf16 v[172:175], v[32:35], v[196:199], v[172:175]
    v_mfma_f32_16x16x32_bf16 v[176:179], v[36:39], v[196:199], v[176:179]
    v_mfma_f32_16x16x32_bf16 v[220:223], v[40:43], v[196:199], v[220:223]
    s_waitcnt vmcnt(10)
    v_mfma_f32_16x16x32_bf16 v[224:227], v[24:27], v[200:203], v[224:227]
    v_mfma_f32_16x16x32_bf16 v[228:231], v[28:31], v[200:203], v[228:231]
    v_mfma_f32_16x16x32_bf16 v[232:235], v[32:35], v[200:203], v[232:235]
    v_mfma_f32_16x16x32_bf16 v[144:147], v[36:39], v[200:203], v[144:147]
    v_mfma_f32_16x16x32_bf16 v[148:151], v[40:43], v[200:203], v[148:151]
    s_barrier
    s_waitcnt vmcnt(9)
    v_mfma_f32_16x16x32_bf16 v[164:167], v[44:47], v[204:207], v[164:167]
    v_mfma_f32_16x16x32_bf16 v[168:171], v[48:51], v[204:207], v[168:171]
    v_mfma_f32_16x16x32_bf16 v[172:175], v[52:55], v[204:207], v[172:175]
    v_mfma_f32_16x16x32_bf16 v[176:179], v[56:59], v[204:207], v[176:179]
    v_mfma_f32_16x16x32_bf16 v[220:223], v[60:63], v[204:207], v[220:223]
    s_waitcnt vmcnt(8)
    v_mfma_f32_16x16x32_bf16 v[224:227], v[44:47], v[208:211], v[224:227]
    v_mfma_f32_16x16x32_bf16 v[228:231], v[48:51], v[208:211], v[228:231]
    v_mfma_f32_16x16x32_bf16 v[232:235], v[52:55], v[208:211], v[232:235]
    v_mfma_f32_16x16x32_bf16 v[144:147], v[56:59], v[208:211], v[144:147]
    v_mfma_f32_16x16x32_bf16 v[148:151], v[60:63], v[208:211], v[148:151]
    s_waitcnt vmcnt(7)
    v_mfma_f32_16x16x32_bf16 v[164:167], v[64:67], v[152:155], v[164:167]
    v_mfma_f32_16x16x32_bf16 v[168:171], v[68:71], v[152:155], v[168:171]
    v_mfma_f32_16x16x32_bf16 v[172:175], v[72:75], v[152:155], v[172:175]
    v_mfma_f32_16x16x32_bf16 v[176:179], v[76:79], v[152:155], v[176:179]
    v_mfma_f32_16x16x32_bf16 v[220:223], v[80:83], v[152:155], v[220:223]
    s_waitcnt vmcnt(6)
    v_mfma_f32_16x16x32_bf16 v[224:227], v[64:67], v[156:159], v[224:227]
    v_mfma_f32_16x16x32_bf16 v[228:231], v[68:71], v[156:159], v[228:231]
    v_mfma_f32_16x16x32_bf16 v[232:235], v[72:75], v[156:159], v[232:235]
    v_mfma_f32_16x16x32_bf16 v[144:147], v[76:79], v[156:159], v[144:147]
    v_mfma_f32_16x16x32_bf16 v[148:151], v[80:83], v[156:159], v[148:151]
    s_waitcnt vmcnt(5)
    v_mfma_f32_16x16x32_bf16 v[164:167], v[84:87], v[212:215], v[164:167]
    v_mfma_f32_16x16x32_bf16 v[168:171], v[88:91], v[212:215], v[168:171]
    v_mfma_f32_16x16x32_bf16 v[172:175], v[92:95], v[212:215], v[172:175]
    v_mfma_f32_16x16x32_bf16 v[176:179], v[96:99], v[212:215], v[176:179]
    v_mfma_f32_16x16x32_bf16 v[220:223], v[100:103], v[212:215], v[220:223]
    s_waitcnt vmcnt(4)
    v_mfma_f32_16x16x32_bf16 v[224:227], v[84:87], v[216:219], v[224:227]
    v_mfma_f32_16x16x32_bf16 v[228:231], v[88:91], v[216:219], v[228:231]
    v_mfma_f32_16x16x32_bf16 v[232:235], v[92:95], v[216:219], v[232:235]
    v_mfma_f32_16x16x32_bf16 v[144:147], v[96:99], v[216:219], v[144:147]
    v_mfma_f32_16x16x32_bf16 v[148:151], v[100:103], v[216:219], v[148:151]
    s_waitcnt vmcnt(3)
    v_mfma_f32_16x16x32_bf16 v[164:167], v[104:107], v[188:191], v[164:167]
    s_waitcnt vmcnt(1)
    v_mfma_f32_16x16x32_bf16 v[164:167], v[124:127], v[180:183], v[164:167]
    v_mfma_f32_16x16x32_bf16 v[168:171], v[108:111], v[188:191], v[168:171]
    v_mfma_f32_16x16x32_bf16 v[168:171], v[128:131], v[180:183], v[168:171]
    v_mfma_f32_16x16x32_bf16 v[172:175], v[112:115], v[188:191], v[172:175]
    v_mfma_f32_16x16x32_bf16 v[172:175], v[132:135], v[180:183], v[172:175]
    v_mfma_f32_16x16x32_bf16 v[176:179], v[116:119], v[188:191], v[176:179]
    v_mfma_f32_16x16x32_bf16 v[176:179], v[136:139], v[180:183], v[176:179]
    s_nop 1
    ds_write_b128 v244, v[164:167] offset:0
    v_mfma_f32_16x16x32_bf16 v[220:223], v[120:123], v[188:191], v[220:223]
    v_mfma_f32_16x16x32_bf16 v[220:223], v[140:143], v[180:183], v[220:223]
    ds_write_b128 v245, v[168:171] offset:1024
    v_mfma_f32_16x16x32_bf16 v[224:227], v[104:107], v[192:195], v[224:227]
    s_waitcnt vmcnt(0)
    v_mfma_f32_16x16x32_bf16 v[224:227], v[124:127], v[184:187], v[224:227]
    ds_write_b128 v246, v[172:175] offset:2048
    v_mfma_f32_16x16x32_bf16 v[228:231], v[108:111], v[192:195], v[228:231]
    v_mfma_f32_16x16x32_bf16 v[228:231], v[128:131], v[184:187], v[228:231]
    ds_write_b128 v247, v[176:179] offset:3072
    v_mfma_f32_16x16x32_bf16 v[232:235], v[112:115], v[192:195], v[232:235]
    v_mfma_f32_16x16x32_bf16 v[232:235], v[132:135], v[184:187], v[232:235]
    ds_write_b128 v248, v[220:223] offset:4096
    v_mfma_f32_16x16x32_bf16 v[144:147], v[116:119], v[192:195], v[144:147]
    v_mfma_f32_16x16x32_bf16 v[144:147], v[136:139], v[184:187], v[144:147]
    ds_write_b128 v244, v[224:227] offset:5120
    v_mfma_f32_16x16x32_bf16 v[148:151], v[120:123], v[192:195], v[148:151]
    v_mfma_f32_16x16x32_bf16 v[148:151], v[140:143], v[184:187], v[148:151]
    ds_write_b128 v245, v[228:231] offset:6144
    s_nop 0
    ds_write_b128 v246, v[232:235] offset:7168
    s_nop 1
    ds_write_b128 v247, v[144:147] offset:8192
    s_nop 1
    ds_write_b128 v248, v[148:151] offset:9216
    s_branch K2_BF
K2_END:
    s_endpgm
CODE_END:
.section .rodata,"a"
.p2align 6
.amdhsa_kernel sequential_preLN__spectral_fnet__dense_activation_squared_relu__prompt_kernel
  .amdhsa_next_free_vgpr 256
  .amdhsa_next_free_sgpr 102
  .amdhsa_accum_offset 256
  .amdhsa_group_segment_fixed_size 0
  .amdhsa_kernarg_size 104
  .amdhsa_user_sgpr_count 2
  .amdhsa_user_sgpr_kernarg_segment_ptr 1
  .amdhsa_system_sgpr_workgroup_id_x 1
.end_amdhsa_kernel
```
